```python
import torch

def _softmax(x, axis=-1):
    return torch.softmax(x, dim=axis)
def _gelu(x):
    return torch.nn.functional.gelu(x, approximate="tanh")
def _silu(x):
    return torch.nn.functional.silu(x)
def _sigmoid(x):
    return torch.sigmoid(x)
def _layernorm(x, axis=-1, eps=1e-5):
    m = x.mean(dim=axis, keepdim=True)
    v = x.var(dim=axis, keepdim=True, unbiased=False)
    return (x - m) / torch.sqrt(v + eps)
def _scatter_add(tgt, idx, src, axis=0):
    return tgt.clone().index_add_(axis, idx, src)
def _segment_sum(src, seg, n):
    out = torch.zeros((n,) + src.shape[1:], dtype=src.dtype)
    return out.index_add_(0, seg, src)
def _pad(x, pw):
    flat = tuple(v for pair in reversed(pw) for v in pair)
    return torch.nn.functional.pad(x, flat)

kernel_name = 'standalone__mpnn_edge_mlp__graph'

def setup_inputs():

    _w = (lambda a: (lambda t: t.to(torch.bfloat16) if t.is_floating_point() else t)(torch.as_tensor(a)))
    N, deg, D, De = 25000, 32, 64, max(16, 1)
    E = N * deg
    return {
        "x": _w((lambda *s: torch.randn(*s, dtype=torch.bfloat16) * 0.05)(N, D)),
        "e_attr": _w((lambda *s: torch.randn(*s, dtype=torch.bfloat16) * 0.4)(E, De)),
        "src": _w((lambda lo, hi, *s: torch.randint(lo, hi, s))(0, N, E).to(torch.int64)),
        "dst": _w((lambda lo, hi, *s: torch.randint(lo, hi, s))(0, N, E).to(torch.int64)),
        "w_msg": _w((lambda *s: torch.randn(*s, dtype=torch.bfloat16) * 0.4)(2 * D + De, D)),
        "w_upd": _w((lambda *s: torch.randn(*s, dtype=torch.bfloat16) * 0.05)(2 * D, D)),
    }

def reference(x, e_attr, src, dst, w_msg, w_upd):
    N, D = x.shape
    m_in = torch.concatenate([x[src], x[dst], e_attr], axis=-1)
    msg = _silu(m_in @ w_msg)
    agg = _segment_sum(msg, dst, N)
    return _silu(torch.concatenate([x, agg], axis=-1) @ w_upd)
```

```asm
; @launch grid=(256,1,1) block=(512,1,1) lds=163840
.amdgcn_target "amdgcn-amd-amdhsa--gfx950"
.text
.globl standalone__mpnn_edge_mlp__graph_kernel
.type standalone__mpnn_edge_mlp__graph_kernel,@function
.p2align 8
standalone__mpnn_edge_mlp__graph_kernel:
    s_cmp_ge_u32 s2, 256
    s_cbranch_scc1 M_END
    s_load_dwordx4 s[56:59], s[0:1], 16
    s_load_dwordx4 s[4:7], s[0:1], 0
    s_load_dwordx4 s[60:63], s[0:1], 32
    s_load_dwordx4 s[8:11], s[0:1], 48
    s_load_dwordx2 s[64:65], s[0:1], 64
    s_memrealtime s[66:67]
    s_setprio 2
    s_getpc_b64 s[52:53]
M_PC:
    s_lshr_b32 s49, s2, 3
    s_lshl_b32 s49, s49, 7
    v_lshrrev_b32 v30, 6, v0
    v_lshlrev_b32 v30, 12, v30
    v_add_u32 v30, s49, v30
    v_min_u32 v30, M_END-M_PC, v30
    v_mov_b32 v31, s53
    v_add_co_u32 v30, vcc, s52, v30
    s_nop 1
    v_addc_co_u32 v31, vcc, 0, v31, vcc
    global_load_dword v7, v[30:31], off
    v_lshlrev_b32 v110, 4, v0
    v_mov_b32 v243, 0x80000000
    v_cmp_gt_u32 vcc, 288, v0
    s_mul_i32 s49, s2, 12800
    s_mov_b64 s[52:53], vcc
    v_cndmask_b32 v113, v243, v110, vcc
    v_cmp_gt_u32 vcc, 512, v0
    s_add_u32 s50, s49, 4608
    s_mov_b64 s[54:55], vcc
    v_cndmask_b32 v114, v243, v110, vcc
    s_mov_b32 s22, 3200000
    s_mov_b32 s23, 0x20000
    s_mov_b32 s30, 3200000
    s_mov_b32 s31, 0x20000
    v_lshlrev_b32 v111, 2, v0
    v_mov_b32 v246, 0
    v_lshrrev_b32 v28, 6, v0
    s_waitcnt lgkmcnt(0)
    s_mov_b32 s20, s58
    s_mov_b32 s21, s59
    s_mov_b32 s28, s56
    s_mov_b32 s29, s57
    buffer_load_dwordx4 v[68:71], v113, s[20:23], s49 offen
    buffer_load_dwordx4 v[72:75], v114, s[20:23], s50 offen
    ds_write_b32 v111, v246 offset:20480
    ds_write_b32 v111, v246
    v_readfirstlane_b32 s40, v28
    s_setprio 0
    s_mov_b32 s36, s10
    s_mov_b32 s37, s11
    s_mov_b32 s38, 256
    s_mov_b32 s39, 0x20000
    s_cmp_lt_u32 s2, 250
    s_cbranch_scc1 S_NOTAG
    s_cmp_lg_u32 s40, 7
    s_cbranch_scc1 S_NOTAG
    s_or_b32 s49, s66, 1
    v_mov_b32 v116, s49
    v_mov_b32 v117, s67
    v_mov_b32 v118, 0
    v_mov_b32 v119, 0
    s_mov_b64 exec, 1
    buffer_atomic_cmpswap_x2 v[116:119], v246, s[36:39], 0 offen sc1
    s_mov_b64 exec, -1
    s_waitcnt vmcnt(0)
S_NOTAG:
    s_mov_b32 s68, s10
    s_mov_b32 s69, s11
    s_add_u32 s10, s64, 0
    s_addc_u32 s11, s65, 0
    s_cmp_lt_u32 s2, 250
    s_cselect_b64 s[52:53], s[52:53], 0
    s_cselect_b64 s[54:55], s[54:55], 0
    v_and_b32 v237, 63, v0
    v_lshlrev_b32 v238, 4, v237
    s_mul_i32 s12, s2, 102400
    s_lshl_b32 s47, s40, 10
    s_mov_b32 s24, s6
    s_mov_b32 s25, s7
    s_mov_b32 s26, 25600000
    s_mov_b32 s27, 0x20000
    s_mul_i32 s49, s2, 12800
    s_add_u32 s50, s49, 4608
    s_waitcnt lgkmcnt(0)
    s_barrier
    buffer_load_dwordx4 v[76:79], v113, s[28:31], s49 offen
    buffer_load_dwordx4 v[80:83], v114, s[28:31], s50 offen
    s_mov_b32 s16, s4
    s_mov_b32 s17, s5
    s_mov_b32 s18, 3200000
    s_mov_b32 s19, 0x20000
    s_mov_b32 s36, s60
    s_mov_b32 s37, s61
    s_mov_b32 s38, 18432
    s_mov_b32 s39, 0x20000
    s_and_b32 s74, s2, 7
    s_lshl_b32 s74, s74, 5
    s_lshr_b32 s49, s2, 3
    s_add_u32 s74, s74, s49
    s_lshl_b32 s49, s74, 17
    s_add_u32 s49, s49, 1337
    s_mul_hi_u32 s42, s49, 3209991
    s_add_u32 s49, s49, 131072
    s_mul_hi_u32 s70, s49, 3209991
    s_min_u32 s70, s70, 25000
    s_sub_u32 s70, s70, s42
    s_and_b32 s41, s40, 1
    s_mul_i32 s43, s74, 98
    s_sub_u32 s43, s43, s42
    s_sub_u32 s43, s43, 9
    s_lshl_b32 s42, s42, 7
    s_mul_i32 s71, s40, 8704
    s_add_u32 s71, s71, 100352
    v_lshrrev_b32 v28, 4, v237
    v_xor_b32 v28, v28, v237
    v_and_b32 v28, 7, v28
    v_and_b32 v29, 0x380, v238
    v_lshl_or_b32 v28, v28, 4, v29
    v_xor_b32 v29, 64, v28
    s_lshl_b32 s49, s40, 11
    s_add_u32 m0, s49, 77824
    s_add_u32 s50, s49, s42
    buffer_load_dwordx4 v28, s[16:19], s50 offen  lds
    buffer_load_dwordx4 v29, s[16:19], s50 offen offset:1024  lds
    s_lshl_b32 s49, s40, 10
    s_add_u32 m0, s49, 2048
    s_mov_b32 s50, -49
    buffer_load_dwordx4 v238, s[36:39], s49 offen lds
    s_mov_b32 s32, s10
    s_mov_b32 s33, s11
    s_mov_b32 s34, 16777216
    s_mov_b32 s35, 0x20000
    v_mov_b32 v245, 1
    v_mov_b32 v35, 0x10000
    v_lshlrev_b32 v112, 23, v0
    v_add_u32 v112, 9, v112
    v_lshlrev_b32 v34, 5, v237
    s_mov_b32 s50, -49
    s_mov_b32 s13, 2097152
    s_mov_b32 s14, 4194304
    s_mov_b32 s15, 6291456
    s_setprio 2
    s_waitcnt vmcnt(5)
    v_mul_u32_u24 v100, 1338, v68
    v_lshlrev_b32_sdwa v84, 2, v100 dst_sel:DWORD dst_unused:UNUSED_PAD src0_sel:DWORD src1_sel:WORD_1
    v_mul_u32_u24 v101, 1338, v69
    v_lshlrev_b32_sdwa v85, 2, v101 dst_sel:DWORD dst_unused:UNUSED_PAD src0_sel:DWORD src1_sel:WORD_1
    v_mul_u32_u24 v102, 1338, v70
    v_lshlrev_b32_sdwa v86, 2, v102 dst_sel:DWORD dst_unused:UNUSED_PAD src0_sel:DWORD src1_sel:WORD_1
    v_mul_u32_u24 v103, 1338, v71
    v_lshlrev_b32_sdwa v87, 2, v103 dst_sel:DWORD dst_unused:UNUSED_PAD src0_sel:DWORD src1_sel:WORD_1
    s_mov_b64 exec, s[52:53]
    ds_add_rtn_u32 v92, v84, v245 offset:20480
    ds_add_rtn_u32 v93, v85, v245 offset:20480
    ds_add_rtn_u32 v94, v86, v245 offset:20480
    ds_add_rtn_u32 v95, v87, v245 offset:20480
    s_mov_b64 exec, -1
    v_mul_u32_u24 v104, 1338, v72
    v_lshlrev_b32_sdwa v88, 2, v104 dst_sel:DWORD dst_unused:UNUSED_PAD src0_sel:DWORD src1_sel:WORD_1
    v_mul_u32_u24 v105, 1338, v73
    v_lshlrev_b32_sdwa v89, 2, v105 dst_sel:DWORD dst_unused:UNUSED_PAD src0_sel:DWORD src1_sel:WORD_1
    v_mul_u32_u24 v106, 1338, v74
    v_lshlrev_b32_sdwa v90, 2, v106 dst_sel:DWORD dst_unused:UNUSED_PAD src0_sel:DWORD src1_sel:WORD_1
    v_mul_u32_u24 v107, 1338, v75
    v_lshlrev_b32_sdwa v91, 2, v107 dst_sel:DWORD dst_unused:UNUSED_PAD src0_sel:DWORD src1_sel:WORD_1
    s_mov_b64 exec, s[54:55]
    ds_add_rtn_u32 v96, v88, v35 offset:20480
    ds_add_rtn_u32 v97, v89, v35 offset:20480
    ds_add_rtn_u32 v98, v90, v35 offset:20480
    ds_add_rtn_u32 v99, v91, v35 offset:20480
    s_mov_b64 exec, -1
    s_add_u32 m0, s47, 37376
    s_add_u32 s49, s47, 0
    s_add_u32 s49, s49, s12
    buffer_load_dwordx4 v238, s[24:27], s49 offen  lds
    s_add_u32 m0, s47, 45568
    s_add_u32 s49, s47, 8192
    s_add_u32 s49, s49, s12
    buffer_load_dwordx4 v238, s[24:27], s49 offen  lds
    s_add_u32 m0, s47, 53760
    s_add_u32 s49, s47, 16384
    s_add_u32 s49, s49, s12
    buffer_load_dwordx4 v238, s[24:27], s49 offen  lds
    s_waitcnt lgkmcnt(0)
    s_barrier
    ds_read_b128 v[120:123], v34 offset:20480
    ds_read_b128 v[124:127], v34 offset:20496
    ds_read_b32 v25, v111 offset:20480
    s_waitcnt vmcnt(6)
    v_mad_i32_i16 v100, v100, s50, v68 op_sel:[1,0,0,0]
    v_lshl_add_u32 v100, v76, 6, v100
    v_add3_u32 v100, v100, v112, 0
    v_mad_i32_i16 v101, v101, s50, v69 op_sel:[1,0,0,0]
    v_lshl_add_u32 v101, v77, 6, v101
    v_add3_u32 v101, v101, v112, s13
    v_mad_i32_i16 v102, v102, s50, v70 op_sel:[1,0,0,0]
    v_lshl_add_u32 v102, v78, 6, v102
    v_add3_u32 v102, v102, v112, s14
    v_mad_i32_i16 v103, v103, s50, v71 op_sel:[1,0,0,0]
    v_lshl_add_u32 v103, v79, 6, v103
    v_add3_u32 v103, v103, v112, s15
    s_waitcnt lgkmcnt(1)
    v_add_u32 v121, v121, v120
    v_add_u32 v122, v122, v121
    v_add_u32 v123, v123, v122
    v_add_u32 v124, v124, v123
    v_add_u32 v125, v125, v124
    v_add_u32 v126, v126, v125
    v_add_u32 v127, v127, v126
    v_mov_b32 v128, v127
    v_mad_i32_i16 v104, v104, s50, v72 op_sel:[1,0,0,0]
    v_lshl_add_u32 v104, v80, 6, v104
    v_add_u32_dpp v128, v128, v128 row_shr:1 row_mask:0xf bank_mask:0xf bound_ctrl:0
    v_add3_u32 v104, v104, v112, 0
    v_mad_i32_i16 v105, v105, s50, v73 op_sel:[1,0,0,0]
    v_add_u32_dpp v128, v128, v128 row_shr:2 row_mask:0xf bank_mask:0xf bound_ctrl:0
    v_lshl_add_u32 v105, v81, 6, v105
    v_add3_u32 v105, v105, v112, s13
    v_add_u32_dpp v128, v128, v128 row_shr:4 row_mask:0xf bank_mask:0xf bound_ctrl:0
    v_mad_i32_i16 v106, v106, s50, v74 op_sel:[1,0,0,0]
    v_lshl_add_u32 v106, v82, 6, v106
    v_add_u32_dpp v128, v128, v128 row_shr:8 row_mask:0xf bank_mask:0xf bound_ctrl:0
    v_add3_u32 v106, v106, v112, s14
    v_mad_i32_i16 v107, v107, s50, v75 op_sel:[1,0,0,0]
    v_add_u32_dpp v128, v128, v128 row_bcast:15 row_mask:0xa bank_mask:0xf
    v_lshl_add_u32 v107, v83, 6, v107
    v_add3_u32 v107, v107, v112, s15
    v_add_u32_dpp v128, v128, v128 row_bcast:31 row_mask:0xc bank_mask:0xf
    v_sub_u32 v128, v128, v127
    v_add_u32 v128, 75497472, v128
    v_add_u32 v127, v126, v128
    v_add_u32 v126, v125, v128
    v_add_u32 v125, v124, v128
    v_add_u32 v124, v123, v128
    v_add_u32 v123, v122, v128
    v_add_u32 v122, v121, v128
    v_add_u32 v121, v120, v128
    v_mov_b32 v120, v128
    ds_write_b128 v34, v[120:123] offset:22528
    ds_write_b128 v34, v[124:127] offset:22544
    ds_read_b32 v68, v84 offset:22528
    ds_read_b32 v69, v85 offset:22528
    ds_read_b32 v70, v86 offset:22528
    ds_read_b32 v71, v87 offset:22528
    ds_read_b32 v72, v88 offset:22528
    ds_read_b32 v73, v89 offset:22528
    ds_read_b32 v74, v90 offset:22528
    ds_read_b32 v75, v91 offset:22528
    ds_read_b32 v24, v111 offset:22528
    s_add_u32 m0, s47, 61952
    s_add_u32 s49, s47, 24576
    s_add_u32 s49, s49, s12
    buffer_load_dwordx4 v238, s[24:27], s49 offen  lds
    s_min_u32 s47, s47, 3072
    s_add_u32 m0, s47, 70144
    s_add_u32 s49, s47, 32768
    s_add_u32 s49, s49, s12
    buffer_load_dwordx4 v238, s[24:27], s49 offen  lds
    s_mov_b64 exec, s[52:53]
    s_waitcnt lgkmcnt(8)
    v_add_u32 v68, v68, v92
    v_lshlrev_b32_sdwa v68, 2, v68 dst_sel:DWORD dst_unused:UNUSED_PAD src0_sel:DWORD src1_sel:WORD_0
    ds_write_b32 v68, v100 offset:24576
    s_waitcnt lgkmcnt(8)
    v_add_u32 v69, v69, v93
    v_lshlrev_b32_sdwa v69, 2, v69 dst_sel:DWORD dst_unused:UNUSED_PAD src0_sel:DWORD src1_sel:WORD_0
    ds_write_b32 v69, v101 offset:24576
    s_waitcnt lgkmcnt(8)
    v_add_u32 v70, v70, v94
    v_lshlrev_b32_sdwa v70, 2, v70 dst_sel:DWORD dst_unused:UNUSED_PAD src0_sel:DWORD src1_sel:WORD_0
    ds_write_b32 v70, v102 offset:24576
    s_waitcnt lgkmcnt(8)
    v_add_u32 v71, v71, v95
    v_lshlrev_b32_sdwa v71, 2, v71 dst_sel:DWORD dst_unused:UNUSED_PAD src0_sel:DWORD src1_sel:WORD_0
    ds_write_b32 v71, v103 offset:24576
    s_mov_b64 exec, s[54:55]
    s_waitcnt lgkmcnt(8)
    v_add_u32 v72, v72, v96
    v_lshlrev_b32_sdwa v72, 2, v72 dst_sel:DWORD dst_unused:UNUSED_PAD src0_sel:DWORD src1_sel:WORD_1
    ds_write_b32 v72, v104 offset:24576
    s_waitcnt lgkmcnt(8)
    v_add_u32 v73, v73, v97
    v_lshlrev_b32_sdwa v73, 2, v73 dst_sel:DWORD dst_unused:UNUSED_PAD src0_sel:DWORD src1_sel:WORD_1
    ds_write_b32 v73, v105 offset:24576
    s_waitcnt lgkmcnt(8)
    v_add_u32 v74, v74, v98
    v_lshlrev_b32_sdwa v74, 2, v74 dst_sel:DWORD dst_unused:UNUSED_PAD src0_sel:DWORD src1_sel:WORD_1
    ds_write_b32 v74, v106 offset:24576
    s_waitcnt lgkmcnt(8)
    v_add_u32 v75, v75, v99
    v_lshlrev_b32_sdwa v75, 2, v75 dst_sel:DWORD dst_unused:UNUSED_PAD src0_sel:DWORD src1_sel:WORD_1
    ds_write_b32 v75, v107 offset:24576
    s_mov_b64 exec, -1
    s_load_dwordx2 s[100:101], s[68:69], 0
    v_lshrrev_b32 v29, 1, v0
    v_lshlrev_b32 v29, 2, v29
    s_waitcnt vmcnt(5) lgkmcnt(0)
    s_barrier
    ds_read_b128 v[68:71], v110 offset:24576
    ds_read_b128 v[72:75], v110 offset:29184
    ds_read_b32 v228, v29 offset:24576
    ds_read_b32 v229, v29 offset:25600
    ds_read_b32 v230, v29 offset:26624
    ds_read_b32 v231, v29 offset:27648
    ds_read_b32 v232, v29 offset:28672
    s_mul_i32 s49, s2, 16384
    s_add_u32 s50, s49, 8192
    v_and_b32 v30, 1, v0
    v_lshlrev_b32 v30, 4, v30
    s_waitcnt lgkmcnt(5)
    buffer_store_dwordx4 v[68:71], v113, s[32:35], s49 offen sc1
    buffer_store_dwordx4 v[72:75], v114, s[32:35], s50 offen sc1
    s_mul_i32 s44, s2, 8448
    s_add_u32 s44, s44, 4456448
    s_mov_b32 s50, 0
    s_cmp_lg_u32 s100, 0
    s_cbranch_scc1 S_TAGD
S_TAGL:
    s_sleep 8
    global_load_dwordx2 v[26:27], v246, s[68:69] sc1
    s_add_u32 s50, s50, 1
    s_cmp_gt_u32 s50, 200000
    s_cbranch_scc1 M_END
    s_waitcnt vmcnt(0)
    v_readfirstlane_b32 s100, v26
    v_readfirstlane_b32 s101, v27
    s_nop 0
    s_cmp_eq_u32 s100, 0
    s_cbranch_scc1 S_TAGL
S_TAGD:
    v_add_u32 v24, 58720256, v24
    v_mov_b32 v26, s100
    v_mov_b32 v27, s101
    buffer_store_dwordx4 v[24:27], v110, s[32:35], s44 offen sc1
    s_movk_i32 s50, 256
    v_cmp_gt_u32 vcc, s50, v0
    v_mov_b32 v32, v110
    v_and_b32 v239, 31, v237
    v_lshrrev_b32 v240, 5, v237
    v_cndmask_b32 v34, v243, v110, vcc
    v_lshlrev_b32 v28, 3, v0
    v_add_u32 v28, 102912, v28
    v_mov_b32 v76, 0
    v_mov_b32 v77, 0
    ds_write_b64 v28, v[76:77]
    v_bfe_u32 v29, v237, 2, 2
    v_lshl_add_u32 v29, v240, 3, v29
    v_lshlrev_b32 v29, 7, v29
    v_and_b32 v31, 3, v237
    v_lshl_add_u32 v244, v31, 3, v29
    v_and_b32 v31, 16, v237
    v_lshl_add_u32 v244, v31, 1, v244
    v_add_u32 v29, v29, v31
    v_and_b32 v31, 1, v237
    v_lshl_add_u32 v29, v31, 5, v29
    v_and_b32 v31, 2, v237
    v_lshl_add_u32 v29, v31, 2, v29
    s_lshl_b32 s49, s41, 6
    v_add_u32 v236, s49, v29
    v_bfe_u32 v241, v239, 1, 3
    v_xor_b32 v241, v241, v240
    v_lshlrev_b32 v241, 4, v241
    v_lshl_or_b32 v241, v239, 7, v241
    s_and_b32 s49, s40, 6
    s_lshl_b32 s49, s49, 11
    s_add_u32 s49, s49, 77824
    v_add_u32 v241, s49, v241
    s_waitcnt lgkmcnt(1)
    v_lshrrev_b32 v228, 21, v228
    v_lshl_add_u32 v228, v228, 5, v30
    v_lshrrev_b32 v229, 21, v229
    v_lshl_add_u32 v229, v229, 5, v30
    v_lshrrev_b32 v230, 21, v230
    v_lshl_add_u32 v230, v230, 5, v30
    v_lshrrev_b32 v231, 21, v231
    v_lshl_add_u32 v231, v231, 5, v30
    v_lshrrev_b32 v232, 21, v232
    v_lshl_add_u32 v232, v232, 5, v30
    s_add_u32 s28, s10, 11665408
    s_addc_u32 s29, s11, 0
    s_mov_b32 s30, 9502720
    s_mov_b32 s31, 0x20000
    s_lshl_b32 s93, s74, 5
    s_mul_i32 s49, s40, 270336
    s_add_u32 s93, s93, s49
    s_add_u32 s93, s93, 4456448
    v_lshrrev_b32 v242, 1, v237
    v_mul_u32_u24 v242, 8416, v242
    v_add_u32 v242, v242, v238
    s_mov_b32 s74, 0xbfb8aa3b
    s_mov_b32 s75, 0xbfb8aa3b
    ds_read_b128 v[36:39], v241
    v_xor_b32 v241, 32, v241
    ds_read_b64_tr_b16 v[132:133], v236 offset:2048
    ds_read_b64_tr_b16 v[134:135], v236 offset:2560
    ds_read_b128 v[40:43], v241
    v_xor_b32 v241, 96, v241
    ds_read_b64_tr_b16 v[136:137], v236 offset:4096
    ds_read_b64_tr_b16 v[138:139], v236 offset:4608
    ds_read_b128 v[44:47], v241
    v_xor_b32 v241, 32, v241
    ds_read_b64_tr_b16 v[140:141], v236 offset:6144
    ds_read_b64_tr_b16 v[142:143], v236 offset:6656
    ds_read_b128 v[48:51], v241
    ds_read_b64_tr_b16 v[144:145], v236 offset:8192
    ds_read_b64_tr_b16 v[146:147], v236 offset:8704
    s_waitcnt lgkmcnt(0)
    v_mfma_f32_32x32x16_bf16 v[148:163], v[132:135], v[36:39], 0
    v_mfma_f32_32x32x16_bf16 v[148:163], v[136:139], v[40:43], v[148:163]
    v_mfma_f32_32x32x16_bf16 v[148:163], v[140:143], v[44:47], v[148:163]
    v_mfma_f32_32x32x16_bf16 v[148:163], v[144:147], v[48:51], v[148:163]
    v_and_b32 v28, 15, v239
    v_mul_u32_u24 v28, 144, v28
    v_lshl_add_u32 v28, v240, 5, v28
    v_lshrrev_b32 v29, 4, v239
    v_mul_u32_u24 v29, 8704, v29
    s_mul_i32 s49, s41, -8640
    s_add_u32 s49, s49, s71
    v_add3_u32 v28, v28, v29, s49
    v_lshrrev_b32 v29, 3, v237
    v_lshl_add_u32 v31, v29, 4, v238
    v_add_u32 v31, s71, v31
    s_lshl_b32 s49, s40, 11
    s_lshl_b32 s50, s70, 7
    v_add_u32 v29, s49, v238
    v_add_u32 v33, 1024, v29
    v_cmp_gt_u32 vcc, s50, v29
    v_cmp_gt_u32 s[52:53], s50, v33
    s_mov_b32 s51, 512
    s_mov_b32 s45, 0
    v_cndmask_b32 v29, v243, v29, vcc
    v_cndmask_b32 v33, v243, v33, s[52:53]
    v_pk_mul_f32 v[148:149], v[148:149], s[74:75]
    v_pk_mul_f32 v[150:151], v[150:151], s[74:75]
    v_pk_mul_f32 v[152:153], v[152:153], s[74:75]
    v_pk_mul_f32 v[154:155], v[154:155], s[74:75]
    v_pk_mul_f32 v[156:157], v[156:157], s[74:75]
    v_pk_mul_f32 v[158:159], v[158:159], s[74:75]
    v_pk_mul_f32 v[160:161], v[160:161], s[74:75]
    v_pk_mul_f32 v[162:163], v[162:163], s[74:75]
    v_cvt_pk_bf16_f32 v148, v148, v149
    v_cvt_pk_bf16_f32 v149, v150, v151
    v_cvt_pk_bf16_f32 v150, v152, v153
    v_cvt_pk_bf16_f32 v151, v154, v155
    v_cvt_pk_bf16_f32 v152, v156, v157
    v_cvt_pk_bf16_f32 v153, v158, v159
    v_cvt_pk_bf16_f32 v154, v160, v161
    v_cvt_pk_bf16_f32 v155, v162, v163
    ds_write_b128 v28, v[148:151]
    ds_write_b128 v28, v[152:155] offset:16
    s_mov_b32 s20, s62
    s_mov_b32 s21, s63
    s_mov_b32 s22, 16384
    s_mov_b32 s23, 0x20000
    s_lshl_b32 s49, s40, 10
    s_add_u32 s49, s49, 8192
    s_add_u32 m0, s49, 2048
    s_lshl_b32 s50, s41, 10
    buffer_load_dwordx4 v238, s[36:39], s49 offen lds
    s_add_u32 s50, s50, 16384
    s_add_u32 m0, s50, 2048
    s_lshl_b32 s49, s40, 11
    buffer_load_dwordx4 v238, s[36:39], s50 offen lds
    s_lshr_b32 s44, s40, 1
    s_mul_i32 s44, s44, 4608
    s_add_u32 s44, s44, s49
    s_add_u32 m0, s44, 129024
    s_nop 0
    buffer_load_dwordx4 v238, s[20:23], s49 offen lds
    buffer_load_dwordx4 v238, s[20:23], s49 offen offset:1024 lds
    s_add_u32 s50, s42, 8388608
    s_waitcnt vmcnt(7) lgkmcnt(0)
    s_barrier
    ds_read_b128 v[84:87], v31
    ds_read_b128 v[88:91], v31 offset:1152
    ds_read_b128 v[100:103], v228 offset:37376
    ds_read_b128 v[104:107], v229 offset:37376
    ds_read_b128 v[108:111], v230 offset:37376
    ds_read_b128 v[112:115], v231 offset:37376
    ds_read_b128 v[116:119], v232 offset:37376
    s_waitcnt lgkmcnt(5)
    buffer_store_dwordx4 v[84:87], v29, s[32:35], s50 offen sc1
    buffer_store_dwordx4 v[88:91], v33, s[32:35], s50 offen sc1
    s_mul_i32 s49, s2, 37120
    s_waitcnt lgkmcnt(4)
    buffer_store_dwordx4 v[100:103], v32, s[28:31], s49 offen sc1
    s_add_u32 s49, s49, 8192
    s_waitcnt lgkmcnt(3)
    buffer_store_dwordx4 v[104:107], v32, s[28:31], s49 offen sc1
    s_add_u32 s49, s49, 8192
    s_waitcnt lgkmcnt(2)
    buffer_store_dwordx4 v[108:111], v32, s[28:31], s49 offen sc1
    s_add_u32 s49, s49, 8192
    s_waitcnt lgkmcnt(1)
    buffer_store_dwordx4 v[112:115], v32, s[28:31], s49 offen sc1
    s_add_u32 s49, s49, 8192
    s_waitcnt lgkmcnt(0)
    buffer_store_dwordx4 v[116:119], v34, s[28:31], s49 offen sc1
    s_add_u32 s49, s49, 8192
S_NOEM:
    s_mov_b32 s92, 1
    s_lshl_b32 s44, s2, 5
    s_add_u32 s44, s44, 6815744
    s_setprio 0
    s_add_u32 s36, s10, 8388608
    s_addc_u32 s37, s11, 0
    s_mov_b32 s38, 3200000
    s_mov_b32 s39, 0x20000
    v_and_b32 v29, 1, v239
    v_lshlrev_b32 v29, 4, v29
    v_mov_b32 v30, 0x3f80
    v_lshlrev_b32 v29, v29, v30
    v_lshrrev_b32 v28, 2, v239
    v_lshlrev_b32 v30, 2, v240
    v_sub_u32 v28, v28, v30
    v_bfe_i32 v30, v239, 1, 1
    v_and_b32 v30, 0xaaaa, v30
    v_or_b32 v168, 0x4444, v30
    v_cmp_eq_u32 vcc, 0, v28
    s_nop 1
    v_cndmask_b32 v164, 0, v29, vcc
    v_cmp_eq_u32 vcc, 1, v28
    s_nop 1
    v_cndmask_b32 v165, 0, v29, vcc
    v_cmp_eq_u32 vcc, 2, v28
    s_nop 1
    v_cndmask_b32 v166, 0, v29, vcc
    v_cmp_eq_u32 vcc, 3, v28
    s_nop 1
    v_cndmask_b32 v167, 0, v29, vcc
    s_mul_i32 s99, s40, 5120
    s_add_u32 s99, s99, 36864
    s_mov_b32 s24, s10
    s_or_b32 s25, s11, 262144
    s_mov_b32 s26, 1114112
    s_mov_b32 s27, 0x20000
    s_sub_u32 s20, s6, 536870912
    s_subb_u32 s21, s7, 0
    s_or_b32 s21, s21, 2097152
    s_mov_b32 s22, 17577216
    s_mov_b32 s23, 0x20000
    s_sub_u32 s73, 11, s40
    s_cmp_lt_u32 s40, 4
    s_cselect_b32 s73, s40, s73
    s_mul_i32 s48, s73, 8704
    s_add_u32 s48, s48, 94208
    s_mov_b32 s13, 0xffffff80
    s_mov_b32 s14, 0x40000000
    s_mov_b32 s15, 16777216
    v_lshlrev_b32 v9, 4, v240
    v_lshlrev_b32 v11, 4, v240
    v_lshlrev_b32 v13, 4, v240
    v_lshlrev_b32 v15, 4, v240
    v_lshrrev_b32 v28, 3, v237
    s_lshl_b32 s49, s73, 7
    v_lshl_add_u32 v1, v28, 4, s49
    v_lshl_add_u32 v2, v239, 2, s49
    v_and_b32 v31, 1, v28
    v_lshlrev_b32 v31, 4, v31
    v_lshl_add_u32 v241, v237, 5, v31
    v_add_u32 v241, s99, v241
    v_and_b32 v29, 4, v28
    v_and_b32 v30, 7, v237
    v_xor_b32 v29, v29, v30
    v_lshlrev_b32 v20, 4, v29
    v_xor_b32 v21, 16, v20
    v_xor_b32 v22, 32, v20
    v_xor_b32 v23, 48, v20
    v_and_b32 v28, 3, v239
    v_lshrrev_b32 v29, 2, v239
    v_lshl_add_u32 v29, v28, 3, v29
    v_lshlrev_b32 v29, 7, v29
    v_add_u32 v29, s48, v29
    v_lshrrev_b32 v30, 4, v239
    v_lshl_or_b32 v28, v30, 2, v28
    v_xor_b32 v28, v28, v240
    v_lshl_add_u32 v16, v28, 4, v29
    v_xor_b32 v17, 32, v16
    v_xor_b32 v18, 64, v16
    v_xor_b32 v19, 0x60, v16
    s_setprio 2
    v_cmp_eq_u32 vcc, 0, v0
    s_mov_b64 exec, vcc
    s_waitcnt vmcnt(0)
    s_barrier
    buffer_store_dwordx2 v[26:27], v246, s[32:35], s44 offen sc1
    s_mov_b64 exec, -1
    s_mov_b32 s49, 0
    buffer_load_dwordx4 v[64:67], v242, s[32:35], s93 offen sc1
    v_add_u32 v236, 126976, v236
    s_mul_i32 s50, s41, 8704
    v_add_u32 v30, s50, v236
    v_subrev_u32 v31, s50, v236
    ds_read_b64_tr_b16 v[76:77], v244 offset:18432
    ds_read_b64_tr_b16 v[78:79], v244 offset:18944
    ds_read_b64_tr_b16 v[80:81], v244 offset:18496
    ds_read_b64_tr_b16 v[82:83], v244 offset:19008
    ds_read_b64_tr_b16 v[212:213], v236 offset:2048
    ds_read_b64_tr_b16 v[214:215], v236 offset:2560
    ds_read_b64_tr_b16 v[216:217], v236 offset:4096
    ds_read_b64_tr_b16 v[218:219], v236 offset:4608
    ds_read_b64_tr_b16 v[220:221], v236 offset:10752
    ds_read_b64_tr_b16 v[222:223], v236 offset:11264
    ds_read_b64_tr_b16 v[224:225], v236 offset:12800
    ds_read_b64_tr_b16 v[226:227], v236 offset:13312
    s_waitcnt lgkmcnt(0)
    v_mfma_f32_32x32x16_bf16 v[180:195], v[212:215], v[36:39], 0
    v_mfma_f32_32x32x16_bf16 v[180:195], v[216:219], v[40:43], v[180:195]
    v_mfma_f32_32x32x16_bf16 v[180:195], v[220:223], v[44:47], v[180:195]
    v_mfma_f32_32x32x16_bf16 v[180:195], v[224:227], v[48:51], v[180:195]
    ds_read_b64_tr_b16 v[196:197], v30 offset:19456
    ds_read_b64_tr_b16 v[198:199], v30 offset:19968
    ds_read_b64_tr_b16 v[200:201], v30 offset:21504
    ds_read_b64_tr_b16 v[202:203], v30 offset:22016
    ds_read_b64_tr_b16 v[204:205], v31 offset:28160
    ds_read_b64_tr_b16 v[206:207], v31 offset:28672
    ds_read_b64_tr_b16 v[208:209], v31 offset:30208
    ds_read_b64_tr_b16 v[210:211], v31 offset:30720
    ds_read_b64_tr_b16 v[132:133], v244 offset:10240
    ds_read_b64_tr_b16 v[134:135], v244 offset:10752
    ds_read_b64_tr_b16 v[136:137], v244 offset:10304
    ds_read_b64_tr_b16 v[138:139], v244 offset:10816
    ds_read_b64_tr_b16 v[140:141], v244 offset:12288
    ds_read_b64_tr_b16 v[142:143], v244 offset:12800
    ds_read_b64_tr_b16 v[144:145], v244 offset:12352
    ds_read_b64_tr_b16 v[146:147], v244 offset:12864
    ds_read_b64_tr_b16 v[148:149], v244 offset:14336
    ds_read_b64_tr_b16 v[150:151], v244 offset:14848
    ds_read_b64_tr_b16 v[152:153], v244 offset:14400
    ds_read_b64_tr_b16 v[154:155], v244 offset:14912
    ds_read_b64_tr_b16 v[156:157], v244 offset:16384
    ds_read_b64_tr_b16 v[158:159], v244 offset:16896
    ds_read_b64_tr_b16 v[160:161], v244 offset:16448
    ds_read_b64_tr_b16 v[162:163], v244 offset:16960
    v_lshlrev_b32 v28, 16, v76
    v_and_b32 v29, 0xffff0000, v76
    v_pk_mul_f32 v[28:29], v[28:29], s[74:75]
    v_cvt_pk_bf16_f32 v172, v28, v29
    v_lshlrev_b32 v28, 16, v77
    v_and_b32 v29, 0xffff0000, v77
    v_pk_mul_f32 v[28:29], v[28:29], s[74:75]
    v_cvt_pk_bf16_f32 v173, v28, v29
    v_lshlrev_b32 v28, 16, v78
    v_and_b32 v29, 0xffff0000, v78
    v_pk_mul_f32 v[28:29], v[28:29], s[74:75]
    v_cvt_pk_bf16_f32 v174, v28, v29
    v_lshlrev_b32 v28, 16, v79
    v_and_b32 v29, 0xffff0000, v79
    v_pk_mul_f32 v[28:29], v[28:29], s[74:75]
    v_cvt_pk_bf16_f32 v175, v28, v29
    v_lshlrev_b32 v28, 16, v80
    v_and_b32 v29, 0xffff0000, v80
    v_pk_mul_f32 v[28:29], v[28:29], s[74:75]
    v_cvt_pk_bf16_f32 v176, v28, v29
    v_lshlrev_b32 v28, 16, v81
    v_and_b32 v29, 0xffff0000, v81
    v_pk_mul_f32 v[28:29], v[28:29], s[74:75]
    v_cvt_pk_bf16_f32 v177, v28, v29
    v_lshlrev_b32 v28, 16, v82
    v_and_b32 v29, 0xffff0000, v82
    v_pk_mul_f32 v[28:29], v[28:29], s[74:75]
    v_cvt_pk_bf16_f32 v178, v28, v29
    v_lshlrev_b32 v28, 16, v83
    v_and_b32 v29, 0xffff0000, v83
    v_pk_mul_f32 v[28:29], v[28:29], s[74:75]
    v_cvt_pk_bf16_f32 v179, v28, v29
    s_mov_b32 s49, 0
    s_waitcnt vmcnt(0)
    s_branch M_POLLC
M_BATCH:
    v_lshrrev_b32 v242, 1, v237
    v_mul_u32_u24 v242, 8416, v242
    v_add_u32 v242, v242, v238
    s_mov_b32 s49, 0
M_POLL:
    s_sleep 4
    buffer_load_dwordx4 v[64:67], v242, s[32:35], s93 offen sc1
    s_add_u32 s49, s49, 1
    s_cmp_gt_u32 s49, 200000
    s_cbranch_scc1 M_END
    s_waitcnt vmcnt(0)
M_POLLC:
    v_cmpx_ne_u64 vcc, s[100:101], v[66:67]
    s_cbranch_execnz M_POLL
    s_mov_b64 exec, -1
    s_lshl_b32 s49, s40, 5
    v_lshrrev_b32 v242, 1, v237
    v_add_lshl_u32 v52, v242, s49, 12
    v_lshl_or_b32 v52, v237, 31, v52
    v_lshl_add_u32 v60, v237, 2, s71
    v_mov_b32 v29, 0xffff
    s_lshl_b32 s4, s40, 10
    s_add_u32 s4, s4, 6815744
    v_lshlrev_b32 v3, 5, v239
    v_and_b32 v57, v29, v65
    v_lshrrev_b32 v58, 16, v65
    v_and_or_b32 v55, v64, v29, v52
    v_add_u32_dpp v57, v57, v57 row_shr:1 row_mask:0xf bank_mask:0xf bound_ctrl:0
    v_add_u32_dpp v58, v58, v58 row_shr:1 row_mask:0xf bank_mask:0xf bound_ctrl:0
    v_lshrrev_b32 v56, 16, v64
    v_add_u32_dpp v57, v57, v57 row_shr:2 row_mask:0xf bank_mask:0xf bound_ctrl:0
    v_add_u32_dpp v58, v58, v58 row_shr:2 row_mask:0xf bank_mask:0xf bound_ctrl:0
    v_or_b32 v56, v56, v52
    v_add_u32_dpp v57, v57, v57 row_shr:4 row_mask:0xf bank_mask:0xf bound_ctrl:0
    v_add_u32_dpp v58, v58, v58 row_shr:4 row_mask:0xf bank_mask:0xf bound_ctrl:0
    v_and_b32 v53, v29, v65
    v_add_u32_dpp v57, v57, v57 row_shr:8 row_mask:0xf bank_mask:0xf bound_ctrl:0
    v_add_u32_dpp v58, v58, v58 row_shr:8 row_mask:0xf bank_mask:0xf bound_ctrl:0
    v_lshrrev_b32 v54, 16, v65
    v_add_u32_dpp v57, v57, v57 row_bcast:15 row_mask:0xa bank_mask:0xf
    v_add_u32_dpp v58, v58, v58 row_bcast:15 row_mask:0xa bank_mask:0xf
    s_nop 0
    v_add_u32_dpp v57, v57, v57 row_bcast:31 row_mask:0xc bank_mask:0xf
    v_add_u32_dpp v58, v58, v58 row_bcast:31 row_mask:0xc bank_mask:0xf
    v_readlane_b32 s3, v57, 63
    v_readlane_b32 s44, v58, 63
    v_sub_u32 v57, v57, v53
    v_sub_u32 v58, v58, v54
    s_add_u32 s44, s44, s3
    v_add_u32 v58, s3, v58
    s_mov_b32 s46, s44
    s_add_u32 s49, s44, s45
    s_cmp_le_u32 s49, s51
    s_cbranch_scc0 M_WIN
    s_cmp_eq_u32 s45, 0
    s_cbranch_scc1 M_NOWIN
M_WIN:
    s_sub_i32 s46, s44, s45
    s_max_i32 s46, s46, 0
    s_min_u32 s46, s46, s51
    s_sub_i32 s3, s3, s45
    s_max_i32 s3, s3, 0
    v_subrev_u32 v59, s45, v57
    v_max_i32 v57, 0, v59
    v_add_u32 v53, v59, v53
    v_min_i32 v53, s51, v53
    v_sub_u32 v53, v53, v57
    v_sub_u32 v59, v57, v59
    v_add_u32 v55, v55, v59
    v_subrev_u32 v59, s45, v58
    v_max_i32 v58, 0, v59
    v_add_u32 v54, v59, v54
    v_min_i32 v54, s51, v54
    v_sub_u32 v54, v54, v58
    v_sub_u32 v59, v58, v59
    v_add_u32 v56, v56, v59
M_NOWIN:
    s_min_u32 s3, s3, 160
    v_lshl_add_u32 v57, v57, 2, s71
    v_add_u32 v30, 1, v55
    v_add_u32 v31, 2, v55
    v_mov_b32 v29, v53
    v_mov_b32 v28, v57
M_EXP0:
    v_cmpx_lt_i32 vcc, 1, v29
    ds_write2_b32 v28, v30, v31 offset0:1 offset1:2
    v_add_u32 v30, 2, v30
    v_add_u32 v31, 2, v31
    v_cmpx_lt_i32 vcc, 3, v29
    ds_write2_b32 v28, v30, v31 offset0:3 offset1:4
    v_add_u32 v30, 2, v30
    v_add_u32 v31, 2, v31
    v_cmpx_lt_i32 vcc, 5, v29
    ds_write2_b32 v28, v30, v31 offset0:5 offset1:6
    v_add_u32 v30, 2, v30
    v_add_u32 v31, 2, v31
    v_cmpx_lt_i32 vcc, 7, v29
    ds_write2_b32 v28, v30, v31 offset0:7 offset1:8
    v_add_u32 v30, 2, v30
    v_add_u32 v31, 2, v31
    v_cmpx_lt_i32 vcc, 9, v29
    v_add_u32 v28, 32, v28
    v_subrev_u32 v29, 8, v29
    s_cbranch_execnz M_EXP0
    s_mov_b64 exec, -1
    v_lshl_add_u32 v58, v58, 2, s71
    v_add_u32 v30, 1, v56
    v_add_u32 v31, 2, v56
    v_mov_b32 v29, v54
    v_mov_b32 v28, v58
M_EXP1:
    v_cmpx_lt_i32 vcc, 1, v29
    ds_write2_b32 v28, v30, v31 offset0:1 offset1:2
    v_add_u32 v30, 2, v30
    v_add_u32 v31, 2, v31
    v_cmpx_lt_i32 vcc, 3, v29
    ds_write2_b32 v28, v30, v31 offset0:3 offset1:4
    v_add_u32 v30, 2, v30
    v_add_u32 v31, 2, v31
    v_cmpx_lt_i32 vcc, 5, v29
    ds_write2_b32 v28, v30, v31 offset0:5 offset1:6
    v_add_u32 v30, 2, v30
    v_add_u32 v31, 2, v31
    v_cmpx_lt_i32 vcc, 7, v29
    ds_write2_b32 v28, v30, v31 offset0:7 offset1:8
    v_add_u32 v30, 2, v30
    v_add_u32 v31, 2, v31
    v_cmpx_lt_i32 vcc, 9, v29
    v_add_u32 v28, 32, v28
    v_subrev_u32 v29, 8, v29
    s_cbranch_execnz M_EXP1
    s_mov_b64 exec, -1
    v_cmpx_lt_i32 vcc, 0, v53
    ds_write_b32 v57, v55
    s_mov_b64 exec, -1
    v_cmpx_lt_i32 vcc, 0, v54
    ds_write_b32 v58, v56
    s_mov_b64 exec, -1
    buffer_load_dwordx2 v[4:5], v3, s[32:35], s4 offen sc1
    ds_read_b32 v75, v60 offset:1792
    ds_read_b32 v74, v60 offset:1536
    ds_read_b32 v73, v60 offset:1280
    ds_read_b32 v72, v60 offset:1024
    ds_read_b32 v71, v60 offset:768
    ds_read_b32 v70, v60 offset:512
    ds_read_b32 v69, v60 offset:256
    ds_read_b32 v68, v60 offset:0
    v_lshl_add_u32 v29, v242, 2, s71
    ds_read_b32 v228, v29 offset:0
    ds_read_b32 v229, v29 offset:128
    ds_read_b32 v230, v29 offset:256
    ds_read_b32 v231, v29 offset:384
    ds_read_b32 v232, v29 offset:512
    s_sub_i32 s49, s46, 448
    v_cmp_gt_i32 s[68:69], s49, v237
    s_sub_i32 s49, s46, 384
    v_cmp_gt_i32 s[66:67], s49, v237
    s_sub_i32 s49, s46, 320
    v_cmp_gt_i32 s[64:65], s49, v237
    s_sub_i32 s49, s46, 256
    v_cmp_gt_i32 s[62:63], s49, v237
    s_sub_i32 s49, s46, 192
    v_cmp_gt_i32 s[60:61], s49, v237
    s_sub_i32 s49, s46, 128
    v_cmp_gt_i32 s[58:59], s49, v237
    s_sub_i32 s49, s46, 64
    v_cmp_gt_i32 s[56:57], s49, v237
    s_sub_i32 s49, s46, 0
    v_cmp_gt_i32 s[54:55], s49, v237
    s_waitcnt lgkmcnt(5)
    v_lshlrev_b32 v83, 2, v75
    v_lshlrev_b32 v82, 2, v74
    v_lshlrev_b32 v81, 2, v73
    v_lshlrev_b32 v80, 2, v72
    v_lshlrev_b32 v79, 2, v71
    v_lshlrev_b32 v78, 2, v70
    v_lshlrev_b32 v77, 2, v69
    v_lshlrev_b32 v76, 2, v68
    s_mov_b32 s49, 0
    s_branch M_FL1
M_FL:
    s_sleep 4
    buffer_load_dwordx2 v[4:5], v3, s[32:35], s4 offen sc1
    s_add_u32 s49, s49, 1
    s_cmp_gt_u32 s49, 200000
    s_cbranch_scc1 M_END
M_FL1:
    s_waitcnt vmcnt(0)
    v_cmpx_ne_u64 vcc, s[100:101], v[4:5]
    s_cbranch_execnz M_FL
M_READY:
    s_cmp_le_u32 s46, 384
    s_cbranch_scc1 M_GA6
    s_cmp_le_u32 s46, 448
    s_cbranch_scc1 M_GA7
    s_mov_b64 exec, s[68:69]
    buffer_load_dword v83, v83, s[32:35], 0 offen sc1
M_GA7:
    s_mov_b64 exec, s[66:67]
    buffer_load_dword v82, v82, s[32:35], 0 offen sc1
M_GA6:
    s_mov_b64 exec, s[64:65]
    buffer_load_dword v81, v81, s[32:35], 0 offen sc1
    s_mov_b64 exec, s[62:63]
    buffer_load_dword v80, v80, s[32:35], 0 offen sc1
    s_mov_b64 exec, s[60:61]
    buffer_load_dword v79, v79, s[32:35], 0 offen sc1
    s_mov_b64 exec, s[58:59]
    buffer_load_dword v78, v78, s[32:35], 0 offen sc1
    s_mov_b64 exec, s[56:57]
    buffer_load_dword v77, v77, s[32:35], 0 offen sc1
    s_mov_b64 exec, s[54:55]
    buffer_load_dword v76, v76, s[32:35], 0 offen sc1
    s_mov_b64 exec, -1
    v_lshrrev_b32 v30, 4, v237
    v_xor_b32 v30, v30, v237
    v_and_b32 v30, 1, v30
    v_lshlrev_b32 v30, 4, v30
    v_mov_b32 v62, s46
    v_mov_b32 v63, s44
    s_waitcnt lgkmcnt(0)
    s_mov_b32 s49, -2936
    v_bfe_u32 v31, v228, 12, 8
    v_mad_i32_i24 v228, v31, s49, v228
    v_lshl_add_u32 v228, v228, 5, v30
    v_bfe_u32 v31, v229, 12, 8
    v_mad_i32_i24 v229, v31, s49, v229
    v_lshl_add_u32 v229, v229, 5, v30
    v_bfe_u32 v31, v230, 12, 8
    v_mad_i32_i24 v230, v31, s49, v230
    v_lshl_add_u32 v230, v230, 5, v30
    v_bfe_u32 v31, v231, 12, 8
    v_mad_i32_i24 v231, v31, s49, v231
    v_lshl_add_u32 v231, v231, 5, v30
    v_bfe_u32 v31, v232, 12, 8
    v_mad_i32_i24 v232, v31, s49, v232
    v_lshl_add_u32 v232, v232, 5, v30
    s_barrier
    s_sub_i32 s49, s3, 0
    s_add_u32 m0, s99, 0
    v_cmpx_gt_i32 vcc, s49, v242
    buffer_load_dwordx4 v228, s[28:31], 0 offen sc1 lds
    s_sub_i32 s49, s3, 32
    s_add_u32 m0, s99, 1024
    v_cmpx_gt_i32 vcc, s49, v242
    buffer_load_dwordx4 v229, s[28:31], 0 offen sc1 lds
    s_sub_i32 s49, s3, 64
    s_add_u32 m0, s99, 2048
    v_cmpx_gt_i32 vcc, s49, v242
    buffer_load_dwordx4 v230, s[28:31], 0 offen sc1 lds
    s_mov_b64 exec, -1
    s_movk_i32 s50, 3200
    v_mov_b32 v28, s15
    v_mov_b32 v30, s43
    s_cmp_le_u32 s46, 384
    s_cbranch_scc1 M_DW6
    s_cmp_le_u32 s46, 448
    s_cbranch_scc1 M_DW7
    v_lshrrev_b32 v91, 31, v75
    v_mad_u32_u24 v91, v91, 49, v30
M_DW7:
    v_lshrrev_b32 v90, 31, v74
    v_mad_u32_u24 v90, v90, 49, v30
M_DW6:
    v_lshrrev_b32 v89, 31, v73
    v_mad_u32_u24 v89, v89, 49, v30
    v_lshrrev_b32 v88, 31, v72
    v_mad_u32_u24 v88, v88, 49, v30
    v_lshrrev_b32 v87, 31, v71
    v_mad_u32_u24 v87, v87, 49, v30
    v_lshrrev_b32 v86, 31, v70
    v_mad_u32_u24 v86, v86, 49, v30
    v_lshrrev_b32 v85, 31, v69
    v_mad_u32_u24 v85, v85, 49, v30
    v_lshrrev_b32 v84, 31, v68
    v_mad_u32_u24 v84, v84, 49, v30
    s_mov_b32 s75, 102912
    s_mov_b64 exec, 1
    ds_add_u32 v246, v62 offset:1152
    ds_max_u32 v246, v63 offset:1168
    s_cmp_le_u32 s46, 384
    s_cbranch_scc1 M_RK6
    s_cmp_le_u32 s46, 448
    s_cbranch_scc1 M_RK7
    s_mov_b64 exec, s[68:69]
    s_waitcnt vmcnt(10)
    v_and_b32 v227, 63, v83
    v_bfe_u32 v59, v83, 18, 3
    v_add_u32 v91, v227, v91
    v_lshl_add_u32 v227, v91, 2, s75
    v_lshl_add_u32 v227, v59, 9, v227
    ds_add_rtn_u32 v99, v227, v245
M_RK7:
    s_mov_b64 exec, s[66:67]
    s_waitcnt vmcnt(9)
    v_and_b32 v226, 63, v82
    v_bfe_u32 v59, v82, 18, 3
    v_add_u32 v90, v226, v90
    v_lshl_add_u32 v226, v90, 2, s75
    v_lshl_add_u32 v226, v59, 9, v226
    ds_add_rtn_u32 v98, v226, v245
M_RK6:
    s_mov_b64 exec, s[64:65]
    s_waitcnt vmcnt(8)
    v_and_b32 v225, 63, v81
    v_bfe_u32 v59, v81, 18, 3
    v_add_u32 v89, v225, v89
    v_lshl_add_u32 v225, v89, 2, s75
    v_lshl_add_u32 v225, v59, 9, v225
    ds_add_rtn_u32 v97, v225, v245
    s_mov_b64 exec, s[62:63]
    s_waitcnt vmcnt(7)
    v_and_b32 v224, 63, v80
    v_bfe_u32 v59, v80, 18, 3
    v_add_u32 v88, v224, v88
    v_lshl_add_u32 v224, v88, 2, s75
    v_lshl_add_u32 v224, v59, 9, v224
    ds_add_rtn_u32 v96, v224, v245
    s_mov_b64 exec, s[60:61]
    s_waitcnt vmcnt(6)
    v_and_b32 v223, 63, v79
    v_bfe_u32 v59, v79, 18, 3
    v_add_u32 v87, v223, v87
    v_lshl_add_u32 v223, v87, 2, s75
    v_lshl_add_u32 v223, v59, 9, v223
    ds_add_rtn_u32 v95, v223, v245
    s_mov_b64 exec, s[58:59]
    s_waitcnt vmcnt(5)
    v_and_b32 v222, 63, v78
    v_bfe_u32 v59, v78, 18, 3
    v_add_u32 v86, v222, v86
    v_lshl_add_u32 v222, v86, 2, s75
    v_lshl_add_u32 v222, v59, 9, v222
    ds_add_rtn_u32 v94, v222, v245
    s_mov_b64 exec, s[56:57]
    s_waitcnt vmcnt(4)
    v_and_b32 v221, 63, v77
    v_bfe_u32 v59, v77, 18, 3
    v_add_u32 v85, v221, v85
    v_lshl_add_u32 v221, v85, 2, s75
    v_lshl_add_u32 v221, v59, 9, v221
    ds_add_rtn_u32 v93, v221, v245
    s_mov_b64 exec, s[54:55]
    s_waitcnt vmcnt(3)
    v_and_b32 v220, 63, v76
    v_bfe_u32 v59, v76, 18, 3
    v_add_u32 v84, v220, v84
    v_lshl_add_u32 v220, v84, 2, s75
    v_lshl_add_u32 v220, v59, 9, v220
    ds_add_rtn_u32 v92, v220, v245
    s_mov_b64 exec, -1
    s_cmp_eq_u32 s40, 0
    s_cbranch_scc1 M_PK0
    s_lshl_b32 s49, s40, 8
    s_add_u32 s49, s49, 102656
    v_lshl_add_u32 v24, v237, 2, s49
    v_mov_b32 v108, 0
    s_waitcnt lgkmcnt(0)
    s_barrier
    s_cmp_gt_u32 s40, 2
    s_cbranch_scc1 M_NOPFX
    ds_read2st64_b32 v[100:101], v24 offset0:0 offset1:2
    ds_read2st64_b32 v[102:103], v24 offset0:4 offset1:6
    ds_read2st64_b32 v[104:105], v24 offset0:8 offset1:10
    s_waitcnt lgkmcnt(0)
    v_mov_b32 v109, v100
    v_add_u32 v110, v109, v101
    v_add_u32 v111, v110, v102
    v_add_u32 v112, v111, v103
    v_add_u32 v113, v112, v104
    v_add_u32 v114, v113, v105
    ds_write2st64_b32 v24, v108, v109 offset0:34 offset1:36
    ds_write2st64_b32 v24, v110, v111 offset0:38 offset1:40
    ds_write2st64_b32 v24, v112, v113 offset0:42 offset1:44
    ds_write2st64_b32 v24, v114, v115 offset0:46 offset1:48
M_NOPFX:
    s_setprio 0
    s_cmp_lt_u32 s40, 4
    s_cbranch_scc1 M_NOFILL
    v_mov_b32 v32, 3221225472
    v_mov_b32 v33, 3221225472
    v_mov_b32 v34, 3221225472
    v_mov_b32 v35, 3221225472
    v_lshlrev_b32 v28, 4, v0
    v_lshlrev_b32 v29, 3, v0
    ds_write_b128 v28, v[32:35] offset:0
    ds_write_b128 v28, v[32:35] offset:4096
    ds_write_b128 v28, v[32:35] offset:8192
    ds_write_b128 v28, v[32:35] offset:12288
    ds_write_b128 v28, v[32:35] offset:16384
    ds_write_b128 v28, v[32:35] offset:20480
    ds_write_b128 v28, v[32:35] offset:24576
    ds_write_b128 v28, v[32:35] offset:28672
    ds_write_b64 v29, v[32:33]
M_NOFILL:
    s_movk_i32 s50, 3200
    s_mov_b32 s74, 179200
    s_cmp_le_u32 s46, 384
    s_cbranch_scc1 M_PB6
    s_cmp_le_u32 s46, 448
    s_cbranch_scc1 M_PB7
    v_bfe_u32 v28, v75, 12, 8
    v_lshrrev_b32 v59, 21, v83
    v_bfe_i32 v29, v75, 11, 1
    v_mad_u32_u24 v59, v28, s50, v59
    v_and_b32 v29, 1152, v29
    v_bfe_u32 v83, v83, 6, 15
    v_add3_u32 v75, v29, v59, s15
    v_lshl_add_u32 v83, v83, 7, v91
    v_lshlrev_b32 v91, 3, v91
M_PB7:
    v_bfe_u32 v28, v74, 12, 8
    v_lshrrev_b32 v59, 21, v82
    v_bfe_i32 v29, v74, 11, 1
    v_mad_u32_u24 v59, v28, s50, v59
    v_and_b32 v29, 1152, v29
    v_bfe_u32 v82, v82, 6, 15
    v_add3_u32 v74, v29, v59, s15
    v_lshl_add_u32 v82, v82, 7, v90
    v_lshlrev_b32 v90, 3, v90
M_PB6:
    v_bfe_u32 v28, v73, 12, 8
    v_lshrrev_b32 v59, 21, v81
    v_bfe_i32 v29, v73, 11, 1
    v_mad_u32_u24 v59, v28, s50, v59
    v_and_b32 v29, 1152, v29
    v_bfe_u32 v81, v81, 6, 15
    v_add3_u32 v73, v29, v59, s15
    v_lshl_add_u32 v81, v81, 7, v89
    v_lshlrev_b32 v89, 3, v89
    v_bfe_u32 v28, v72, 12, 8
    v_lshrrev_b32 v59, 21, v80
    v_bfe_i32 v29, v72, 11, 1
    v_mad_u32_u24 v59, v28, s50, v59
    v_and_b32 v29, 1152, v29
    v_bfe_u32 v80, v80, 6, 15
    v_add3_u32 v72, v29, v59, s15
    v_lshl_add_u32 v80, v80, 7, v88
    v_lshlrev_b32 v88, 3, v88
    v_bfe_u32 v28, v71, 12, 8
    v_lshrrev_b32 v59, 21, v79
    v_bfe_i32 v29, v71, 11, 1
    v_mad_u32_u24 v59, v28, s50, v59
    v_and_b32 v29, 1152, v29
    v_bfe_u32 v79, v79, 6, 15
    v_add3_u32 v71, v29, v59, s15
    v_lshl_add_u32 v79, v79, 7, v87
    v_lshlrev_b32 v87, 3, v87
    v_bfe_u32 v28, v70, 12, 8
    v_lshrrev_b32 v59, 21, v78
    v_bfe_i32 v29, v70, 11, 1
    v_mad_u32_u24 v59, v28, s50, v59
    v_and_b32 v29, 1152, v29
    v_bfe_u32 v78, v78, 6, 15
    v_add3_u32 v70, v29, v59, s15
    v_lshl_add_u32 v78, v78, 7, v86
    v_lshlrev_b32 v86, 3, v86
    s_sub_i32 s49, s3, 128
    v_cmp_gt_i32 vcc, s49, v237
    v_add_u32 v59, 4096, v241
    s_nop 0
    v_cndmask_b32 v70, v70, v59, vcc
    v_bfe_u32 v28, v69, 12, 8
    v_lshrrev_b32 v59, 21, v77
    v_bfe_i32 v29, v69, 11, 1
    v_mad_u32_u24 v59, v28, s50, v59
    v_and_b32 v29, 1152, v29
    v_bfe_u32 v77, v77, 6, 15
    v_add3_u32 v69, v29, v59, s15
    v_lshl_add_u32 v77, v77, 7, v85
    v_lshlrev_b32 v85, 3, v85
    s_sub_i32 s49, s3, 64
    v_cmp_gt_i32 vcc, s49, v237
    v_add_u32 v59, 2048, v241
    s_nop 0
    v_cndmask_b32 v69, v69, v59, vcc
    v_bfe_u32 v28, v68, 12, 8
    v_lshrrev_b32 v59, 21, v76
    v_bfe_i32 v29, v68, 11, 1
    v_mad_u32_u24 v59, v28, s50, v59
    v_and_b32 v29, 1152, v29
    v_bfe_u32 v76, v76, 6, 15
    v_add3_u32 v68, v29, v59, s15
    v_lshl_add_u32 v76, v76, 7, v84
    v_lshlrev_b32 v84, 3, v84
    s_sub_i32 s49, s3, 0
    v_cmp_gt_i32 vcc, s49, v237
    v_add_u32 v59, 0, v241
    s_nop 0
    v_cndmask_b32 v68, v68, v59, vcc
    s_sub_i32 s49, s3, 96
    s_add_u32 m0, s99, 3072
    v_cmpx_gt_i32 vcc, s49, v242
    buffer_load_dwordx4 v231, s[28:31], 0 offen sc1 lds
    s_sub_i32 s49, s3, 128
    s_add_u32 m0, s99, 4096
    v_cmpx_gt_i32 vcc, s49, v242
    buffer_load_dwordx4 v232, s[28:31], 0 offen sc1 lds
    s_mov_b64 exec, -1
    s_mov_b64 exec, s[66:67]
    v_cmpx_gt_u32 vcc, s74, v82
    buffer_load_dword v7, v74, s[20:23], 0 idxen
    s_mov_b64 exec, s[64:65]
    v_cmpx_gt_u32 vcc, s74, v81
    buffer_load_dword v7, v73, s[20:23], 0 idxen
    s_mov_b64 exec, s[62:63]
    v_cmpx_gt_u32 vcc, s74, v80
    buffer_load_dword v7, v72, s[20:23], 0 idxen
    s_mov_b64 exec, s[60:61]
    v_cmpx_gt_u32 vcc, s74, v79
    buffer_load_dword v7, v71, s[20:23], 0 idxen
    s_mov_b64 exec, s[58:59]
    v_cmpx_gt_u32 vcc, s74, v78
    v_cmpx_le_u32 vcc, s15, v70
    buffer_load_dword v7, v70, s[20:23], 0 idxen
    s_mov_b64 exec, -1
    s_waitcnt lgkmcnt(0)
    s_barrier
    s_branch M_P4E
M_PK0:
    s_setprio 3
    v_lshlrev_b32 v109, 3, v237
    v_lshlrev_b32 v114, 2, v237
    v_add_u32 v114, 102912, v114
    v_sub_u32 v115, 31, v239
    v_lshlrev_b32 v115, 2, v115
    s_mov_b32 s75, 0x4a800000
    s_waitcnt lgkmcnt(0)
    s_barrier
    ds_read_b32 v108, v246 offset:1152
    ds_read2st64_b32 v[36:37], v114 offset0:0 offset1:1
    ds_read2st64_b32 v[38:39], v114 offset0:2 offset1:3
    ds_read2st64_b32 v[40:41], v114 offset0:4 offset1:5
    ds_read2st64_b32 v[42:43], v114 offset0:6 offset1:7
    ds_read2st64_b32 v[44:45], v114 offset0:8 offset1:9
    ds_read2st64_b32 v[46:47], v114 offset0:10 offset1:11
    ds_read2st64_b32 v[48:49], v114 offset0:12 offset1:13
    s_waitcnt lgkmcnt(4)
    v_readfirstlane_b32 s12, v108
    v_add3_u32 v100, v36, v38, v40
    v_add3_u32 v101, v37, v39, v41
    s_lshr_b32 s12, s12, 8
    s_add_u32 s12, s12, 1
    s_waitcnt lgkmcnt(0)
    v_add3_u32 v100, v100, v42, v44
    v_add3_u32 v101, v101, v43, v45
    v_add3_u32 v100, v100, v46, v48
    v_add3_u32 v101, v101, v47, v49
    v_cvt_f32_u32 v102, v100
    v_cvt_f32_u32 v103, v101
    v_add_f32 v102, -0.5, v102
    v_add_f32 v103, -0.5, v103
M_LS:
    s_add_u32 s12, s12, 2
    s_cmp_gt_u32 s12, 17
    s_cbranch_scc1 M_P4W
    v_cvt_f32_u32 v37, s12
    v_add_f32 v36, -1.0, v37
    v_add_f32 v38, 1.0, v37
    v_rcp_f32 v39, v36
    v_rcp_f32 v40, v37
    v_rcp_f32 v41, v38
    v_fma_f32 v42, v102, v39, 1.0
    v_fma_f32 v43, v103, v39, 1.0
    v_fma_f32 v44, v102, v40, 1.0
    v_fma_f32 v45, v103, v40, 1.0
    v_fma_f32 v46, v102, v41, 1.0
    v_fma_f32 v47, v103, v41, 1.0
    v_cvt_u32_f32 v42, v42
    v_cvt_u32_f32 v43, v43
    v_cvt_u32_f32 v44, v44
    v_cvt_u32_f32 v45, v45
    v_cvt_u32_f32 v46, v46
    v_cvt_u32_f32 v47, v47
    v_lshl_or_b32 v104, v44, 10, v42
    v_lshl_or_b32 v105, v45, 10, v43
    v_lshl_or_b32 v104, v46, 20, v104
    v_lshl_or_b32 v105, v47, 20, v105
    v_add_u32 v108, v104, v105
    s_nop 1
    v_add_u32_dpp v108, v108, v108 row_shr:1 row_mask:0xf bank_mask:0xf bound_ctrl:0
    s_nop 1
    v_add_u32_dpp v108, v108, v108 row_shr:2 row_mask:0xf bank_mask:0xf bound_ctrl:0
    s_nop 1
    v_add_u32_dpp v108, v108, v108 row_shr:4 row_mask:0xf bank_mask:0xf bound_ctrl:0
    s_nop 1
    v_add_u32_dpp v108, v108, v108 row_shr:8 row_mask:0xf bank_mask:0xf bound_ctrl:0
    s_nop 1
    v_add_u32_dpp v108, v108, v108 row_bcast:15 row_mask:0xa bank_mask:0xf
    s_nop 1
    v_add_u32_dpp v108, v108, v108 row_bcast:31 row_mask:0xc bank_mask:0xf
    v_sub_u32 v106, v108, v105
    v_readlane_b32 s49, v108, 63
    s_mov_b32 s50, 0
    s_bfe_u32 s52, s49, 0xa000a
    s_cmp_le_u32 s52, 256
    s_cbranch_scc1 M_LOK
    s_lshr_b32 s52, s49, 20
    s_cmp_gt_u32 s52, 256
    s_cbranch_scc1 M_LS
    s_mov_b32 s50, 10
    s_add_u32 s12, s12, 1
    s_cmp_gt_u32 s12, 17
    s_cbranch_scc1 M_P4W
M_LOK:
    s_sub_u32 s52, 256, s52
    s_add_u32 s53, s50, 10
    v_bfe_u32 v110, v106, s50, 10
    v_bfe_u32 v111, v108, s50, 10
    v_bfe_u32 v106, v106, s53, 10
    v_bfe_u32 v107, v108, s53, 10
    v_sub_u32 v110, v110, v106
    v_sub_u32 v111, v111, v107
    v_mov_b32 v106, s53
    v_mov_b32 v107, s50
    v_cmp_ge_u32 vcc, s52, v110
    v_cmp_ge_u32 s[52:53], s52, v111
    s_nop 0
    v_cndmask_b32 v110, v106, v107, vcc
    v_cndmask_b32 v111, v106, v107, s[52:53]
    v_bfe_u32 v104, v104, v110, 10
    v_bfe_u32 v105, v105, v111, 10
    v_cvt_f32_u32 v110, v104
    v_cvt_f32_u32 v111, v105
    v_rcp_f32 v24, v110
    v_rcp_f32 v26, v111
    s_nop 0
    v_fma_f32 v110, v102, v24, 1.0
    v_fma_f32 v111, v103, v26, 1.0
    v_cvt_u32_f32 v110, v110
    v_cvt_u32_f32 v111, v111
    v_lshlrev_b32 v110, 2, v110
    v_lshlrev_b32 v111, 2, v111
    ds_add_rtn_u32 v112, v110, v104 offset:1024
    ds_add_rtn_u32 v113, v111, v105 offset:1024
    ds_read_b32 v114, v115 offset:1024
    v_mul_f32 v24, s75, v24
    v_mul_f32 v26, s75, v26
    v_cvt_u32_f32 v24, v24
    v_cvt_u32_f32 v26, v26
    v_add_u32 v24, 2, v24
    v_add_u32 v26, 2, v26
    v_lshlrev_b32 v25, 2, v104
    v_lshlrev_b32 v27, 2, v105
    v_sub_u32 v25, 1024, v25
    v_sub_u32 v27, 1024, v27
    v_sub_u32 v110, 124, v110
    v_sub_u32 v111, 124, v111
    s_waitcnt lgkmcnt(0)
    v_mov_b32 v108, v114
    s_nop 1
    v_add_u32_dpp v108, v108, v108 row_shr:1 row_mask:0xf bank_mask:0xf bound_ctrl:0
    s_nop 1
    v_add_u32_dpp v108, v108, v108 row_shr:2 row_mask:0xf bank_mask:0xf bound_ctrl:0
    s_nop 1
    v_add_u32_dpp v108, v108, v108 row_shr:4 row_mask:0xf bank_mask:0xf bound_ctrl:0
    s_nop 1
    v_add_u32_dpp v108, v108, v108 row_shr:8 row_mask:0xf bank_mask:0xf bound_ctrl:0
    s_nop 1
    v_add_u32_dpp v108, v108, v108 row_bcast:15 row_mask:0xa bank_mask:0xf
    v_sub_u32 v108, v108, v114
    ds_bpermute_b32 v100, v110, v108
    ds_bpermute_b32 v101, v111, v108
    ds_write_b32 v115, v108 offset:1184
    s_waitcnt lgkmcnt(1)
    v_add_u32 v112, v112, v100
    v_add_u32 v113, v113, v101
    v_lshl_or_b32 v24, v112, 24, v24
    v_lshl_or_b32 v26, v113, 24, v26
    ds_write2st64_b64 v109, v[24:25], v[26:27] offset0:0 offset1:1
M_P4W:
    v_mov_b32 v108, s12
    ds_write_b32 v246, v108 offset:1172
    s_waitcnt lgkmcnt(0)
    s_barrier
    s_sub_i32 s49, s3, 96
    s_add_u32 m0, s99, 3072
    v_cmpx_gt_i32 vcc, s49, v242
    buffer_load_dwordx4 v231, s[28:31], 0 offen sc1 lds
    s_sub_i32 s49, s3, 128
    s_add_u32 m0, s99, 4096
    v_cmpx_gt_i32 vcc, s49, v242
    buffer_load_dwordx4 v232, s[28:31], 0 offen sc1 lds
    s_mov_b64 exec, -1
    s_movk_i32 s50, 3200
    s_mov_b32 s74, 179200
    s_cmp_le_u32 s46, 384
    s_cbranch_scc1 M_PA6
    s_cmp_le_u32 s46, 448
    s_cbranch_scc1 M_PA7
    v_bfe_u32 v28, v75, 12, 8
    v_lshrrev_b32 v59, 21, v83
    v_bfe_i32 v29, v75, 11, 1
    v_mad_u32_u24 v59, v28, s50, v59
    v_and_b32 v29, 1152, v29
    v_bfe_u32 v83, v83, 6, 15
    v_add3_u32 v75, v29, v59, s15
    v_lshl_add_u32 v83, v83, 7, v91
    v_lshlrev_b32 v91, 3, v91
M_PA7:
    v_bfe_u32 v28, v74, 12, 8
    v_lshrrev_b32 v59, 21, v82
    v_bfe_i32 v29, v74, 11, 1
    v_mad_u32_u24 v59, v28, s50, v59
    v_and_b32 v29, 1152, v29
    v_bfe_u32 v82, v82, 6, 15
    v_add3_u32 v74, v29, v59, s15
    v_lshl_add_u32 v82, v82, 7, v90
    v_lshlrev_b32 v90, 3, v90
M_PA6:
    v_bfe_u32 v28, v73, 12, 8
    v_lshrrev_b32 v59, 21, v81
    v_bfe_i32 v29, v73, 11, 1
    v_mad_u32_u24 v59, v28, s50, v59
    v_and_b32 v29, 1152, v29
    v_bfe_u32 v81, v81, 6, 15
    v_add3_u32 v73, v29, v59, s15
    v_lshl_add_u32 v81, v81, 7, v89
    v_lshlrev_b32 v89, 3, v89
    v_bfe_u32 v28, v72, 12, 8
    v_lshrrev_b32 v59, 21, v80
    v_bfe_i32 v29, v72, 11, 1
    v_mad_u32_u24 v59, v28, s50, v59
    v_and_b32 v29, 1152, v29
    v_bfe_u32 v80, v80, 6, 15
    v_add3_u32 v72, v29, v59, s15
    v_lshl_add_u32 v80, v80, 7, v88
    v_lshlrev_b32 v88, 3, v88
    v_bfe_u32 v28, v71, 12, 8
    v_lshrrev_b32 v59, 21, v79
    v_bfe_i32 v29, v71, 11, 1
    v_mad_u32_u24 v59, v28, s50, v59
    v_and_b32 v29, 1152, v29
    v_bfe_u32 v79, v79, 6, 15
    v_add3_u32 v71, v29, v59, s15
    v_lshl_add_u32 v79, v79, 7, v87
    v_lshlrev_b32 v87, 3, v87
    v_bfe_u32 v28, v70, 12, 8
    v_lshrrev_b32 v59, 21, v78
    v_bfe_i32 v29, v70, 11, 1
    v_mad_u32_u24 v59, v28, s50, v59
    v_and_b32 v29, 1152, v29
    v_bfe_u32 v78, v78, 6, 15
    v_add3_u32 v70, v29, v59, s15
    v_lshl_add_u32 v78, v78, 7, v86
    v_lshlrev_b32 v86, 3, v86
    s_sub_i32 s49, s3, 128
    v_cmp_gt_i32 vcc, s49, v237
    v_add_u32 v59, 4096, v241
    s_nop 0
    v_cndmask_b32 v70, v70, v59, vcc
    v_bfe_u32 v28, v69, 12, 8
    v_lshrrev_b32 v59, 21, v77
    v_bfe_i32 v29, v69, 11, 1
    v_mad_u32_u24 v59, v28, s50, v59
    v_and_b32 v29, 1152, v29
    v_bfe_u32 v77, v77, 6, 15
    v_add3_u32 v69, v29, v59, s15
    v_lshl_add_u32 v77, v77, 7, v85
    v_lshlrev_b32 v85, 3, v85
    s_sub_i32 s49, s3, 64
    v_cmp_gt_i32 vcc, s49, v237
    v_add_u32 v59, 2048, v241
    s_nop 0
    v_cndmask_b32 v69, v69, v59, vcc
    v_bfe_u32 v28, v68, 12, 8
    v_lshrrev_b32 v59, 21, v76
    v_bfe_i32 v29, v68, 11, 1
    v_mad_u32_u24 v59, v28, s50, v59
    v_and_b32 v29, 1152, v29
    v_bfe_u32 v76, v76, 6, 15
    v_add3_u32 v68, v29, v59, s15
    v_lshl_add_u32 v76, v76, 7, v84
    v_lshlrev_b32 v84, 3, v84
    s_sub_i32 s49, s3, 0
    v_cmp_gt_i32 vcc, s49, v237
    v_add_u32 v59, 0, v241
    s_nop 0
    v_cndmask_b32 v68, v68, v59, vcc
    s_mov_b64 exec, s[66:67]
    v_cmpx_gt_u32 vcc, s74, v82
    buffer_load_dword v7, v74, s[20:23], 0 idxen
    s_mov_b64 exec, s[64:65]
    v_cmpx_gt_u32 vcc, s74, v81
    buffer_load_dword v7, v73, s[20:23], 0 idxen
    s_mov_b64 exec, s[62:63]
    v_cmpx_gt_u32 vcc, s74, v80
    buffer_load_dword v7, v72, s[20:23], 0 idxen
    s_mov_b64 exec, s[60:61]
    v_cmpx_gt_u32 vcc, s74, v79
    buffer_load_dword v7, v71, s[20:23], 0 idxen
    s_mov_b64 exec, s[58:59]
    v_cmpx_gt_u32 vcc, s74, v78
    v_cmpx_le_u32 vcc, s15, v70
    buffer_load_dword v7, v70, s[20:23], 0 idxen
    s_mov_b64 exec, -1
M_P4E:
    ds_read_b64 v[120:121], v246 offset:1168
    v_lshlrev_b32 v59, 2, v239
    ds_read_b32 v122, v59 offset:1024
    ds_read_b32 v123, v59 offset:1184
    s_lshr_b32 s49, s40, 1
    s_lshl_b32 s49, s49, 5
    v_add_u32 v126, s49, v239
    v_lshlrev_b32 v59, 3, v126
    ds_read_b64 v[124:125], v59 offset:0
    s_cmp_le_u32 s46, 384
    s_cbranch_scc1 M_TR6
    s_cmp_le_u32 s46, 448
    s_cbranch_scc1 M_TR7
    s_mov_b64 exec, s[68:69]
    ds_read_b64 v[50:51], v91 offset:0
    ds_read_b32 v219, v227 offset:8704
M_TR7:
    s_mov_b64 exec, s[66:67]
    ds_read_b64 v[48:49], v90 offset:0
    ds_read_b32 v218, v226 offset:8704
M_TR6:
    s_mov_b64 exec, s[64:65]
    ds_read_b64 v[46:47], v89 offset:0
    ds_read_b32 v217, v225 offset:8704
    s_mov_b64 exec, s[62:63]
    ds_read_b64 v[44:45], v88 offset:0
    ds_read_b32 v216, v224 offset:8704
    s_mov_b64 exec, s[60:61]
    ds_read_b64 v[42:43], v87 offset:0
    ds_read_b32 v215, v223 offset:8704
    s_mov_b64 exec, s[58:59]
    ds_read_b64 v[40:41], v86 offset:0
    ds_read_b32 v214, v222 offset:8704
    s_mov_b64 exec, s[56:57]
    ds_read_b64 v[38:39], v85 offset:0
    ds_read_b32 v213, v221 offset:8704
    s_mov_b64 exec, s[54:55]
    ds_read_b64 v[36:37], v84 offset:0
    ds_read_b32 v212, v220 offset:8704
    s_mov_b64 exec, -1
    s_lshl_b32 s49, s73, 5
    s_waitcnt lgkmcnt(12)
    v_readfirstlane_b32 s72, v120
    v_readfirstlane_b32 s12, v121
    v_add_u32 v122, v122, v123
    v_cmp_ge_u32 vcc, s49, v123
    v_cmp_lt_u32 s[52:53], s49, v122
    s_and_b64 s[52:53], s[52:53], vcc
    s_ff1_i32_b32 s47, s52
    s_max_i32 s47, s47, 0
    s_cmp_le_u32 s12, 17
    s_cbranch_scc1 M_P5
    s_mov_b32 s51, 256
    s_branch M_AGAIN
M_P5:
    s_cmp_le_u32 s46, 384
    s_cbranch_scc1 M_SC6
    s_cmp_le_u32 s46, 448
    s_cbranch_scc1 M_SC7
    s_mov_b64 exec, s[68:69]
    s_waitcnt lgkmcnt(14)
    v_add_u32 v99, v99, v219
    v_lshrrev_b32 v59, 24, v50
    v_mul_u32_u24 v50, v50, v99
    v_add_lshl_u32 v59, v59, v99, 2
    v_lshrrev_b32 v50, 22, v50
    v_mad_u32_u24 v59, v50, v51, v59
    ds_write2st64_b32 v59, v83, v75 offset0:8 offset1:76
M_SC7:
    s_mov_b64 exec, s[66:67]
    s_waitcnt lgkmcnt(12)
    v_add_u32 v98, v98, v218
    v_lshrrev_b32 v59, 24, v48
    v_mul_u32_u24 v48, v48, v98
    v_add_lshl_u32 v59, v59, v98, 2
    v_lshrrev_b32 v48, 22, v48
    v_mad_u32_u24 v59, v48, v49, v59
    ds_write2st64_b32 v59, v82, v74 offset0:8 offset1:76
M_SC6:
    s_mov_b64 exec, s[64:65]
    s_waitcnt lgkmcnt(10)
    v_add_u32 v97, v97, v217
    v_lshrrev_b32 v59, 24, v46
    v_mul_u32_u24 v46, v46, v97
    v_add_lshl_u32 v59, v59, v97, 2
    v_lshrrev_b32 v46, 22, v46
    v_mad_u32_u24 v59, v46, v47, v59
    ds_write2st64_b32 v59, v81, v73 offset0:8 offset1:76
    s_mov_b64 exec, s[62:63]
    s_waitcnt lgkmcnt(9)
    v_add_u32 v96, v96, v216
    v_lshrrev_b32 v59, 24, v44
    v_mul_u32_u24 v44, v44, v96
    v_add_lshl_u32 v59, v59, v96, 2
    v_lshrrev_b32 v44, 22, v44
    v_mad_u32_u24 v59, v44, v45, v59
    ds_write2st64_b32 v59, v80, v72 offset0:8 offset1:76
    s_mov_b64 exec, s[60:61]
    s_waitcnt lgkmcnt(8)
    v_add_u32 v95, v95, v215
    v_lshrrev_b32 v59, 24, v42
    v_mul_u32_u24 v42, v42, v95
    v_add_lshl_u32 v59, v59, v95, 2
    v_lshrrev_b32 v42, 22, v42
    v_mad_u32_u24 v59, v42, v43, v59
    ds_write2st64_b32 v59, v79, v71 offset0:8 offset1:76
    s_mov_b64 exec, s[58:59]
    s_waitcnt lgkmcnt(7)
    v_add_u32 v94, v94, v214
    v_lshrrev_b32 v59, 24, v40
    v_mul_u32_u24 v40, v40, v94
    v_add_lshl_u32 v59, v59, v94, 2
    v_lshrrev_b32 v40, 22, v40
    v_mad_u32_u24 v59, v40, v41, v59
    ds_write2st64_b32 v59, v78, v70 offset0:8 offset1:76
    s_mov_b64 exec, s[56:57]
    s_waitcnt lgkmcnt(6)
    v_add_u32 v93, v93, v213
    v_lshrrev_b32 v59, 24, v38
    v_mul_u32_u24 v38, v38, v93
    v_add_lshl_u32 v59, v59, v93, 2
    v_lshrrev_b32 v38, 22, v38
    v_mad_u32_u24 v59, v38, v39, v59
    ds_write2st64_b32 v59, v77, v69 offset0:8 offset1:76
    s_mov_b64 exec, s[54:55]
    s_waitcnt lgkmcnt(5)
    v_add_u32 v92, v92, v212
    v_lshrrev_b32 v59, 24, v36
    v_mul_u32_u24 v36, v36, v92
    v_add_lshl_u32 v59, v59, v92, 2
    v_lshrrev_b32 v36, 22, v36
    v_mad_u32_u24 v59, v36, v37, v59
    ds_write2st64_b32 v59, v76, v68 offset0:8 offset1:76
    s_mov_b64 exec, -1
    s_setprio 0
    s_waitcnt vmcnt(5) lgkmcnt(0)
    s_barrier
    s_cmp_lg_u32 s47, 0
    s_cbranch_scc1 M_GO
    s_lshl_b32 s49, s41, 7
    s_add_u32 s49, s49, 94208
    s_movk_i32 s50, 0x3fc
    s_movk_i32 s75, 0x3f8
    v_mov_b32 v216, v125
    v_lshrrev_b32 v212, 24, v124
    v_mul_u32_u24 v212, 272, v212
    v_lshl_add_u32 v212, v9, 1, v212
    v_add_u32 v212, s49, v212
    v_mov_b32 v219, 1536
    v_cmp_gt_u32 s[56:57], s50, v216
    v_cmp_gt_u32 s[58:59], s75, v216
    v_add_u32 v213, 272, v212
    v_add_u32 v214, 544, v212
    v_add_u32 v215, 816, v212
    v_cmp_gt_u32 vcc, 0x400, v216
    v_cndmask_b32 v213, v219, v213, s[56:57]
    v_cndmask_b32 v214, v219, v214, s[58:59]
    v_cndmask_b32 v212, v219, v212, vcc
    v_cmp_gt_u32 vcc, s70, v126
    v_lshlrev_b32 v217, 7, v126
    v_lshl_add_u32 v217, v9, 1, v217
    s_lshl_b32 s49, s40, 11
    v_cndmask_b32 v217, v243, v217, vcc
    v_add_u32 v218, s49, v238
    v_mul_u32_u24 v219, 272, v239
    v_add3_u32 v219, v219, v9, s48
    s_branch M_BEND
M_GO:
    s_lshl_b32 s49, s73, 7
    v_lshrrev_b32 v1, 3, v237
    v_lshl_add_u32 v1, v1, 4, s49
    v_lshl_add_u32 v2, v239, 2, s49
    ds_read_b128 v[24:27], v1 offset:2048
    ds_read_b32 v68, v2 offset:2048
    ds_read_b32 v8, v2 offset:19456
    ds_read_b32 v10, v2 offset:20480
    ds_read_b128 v[72:75], v1 offset:3072
    ds_read_b128 v[228:231], v1 offset:4096
    s_waitcnt lgkmcnt(4)
    v_and_or_b32 v24, v24, s13, v20
    v_and_or_b32 v25, v25, s13, v21
    v_and_or_b32 v26, v26, s13, v22
    v_and_or_b32 v27, v27, s13, v23
    s_add_u32 m0, s48, 0
    v_and_b32 v69, 127, v68
    buffer_load_dwordx4 v24, s[36:39], 0 offen sc1 lds
    s_add_u32 m0, s48, 1024
    v_lshlrev_b32 v69, 7, v69
    buffer_load_dwordx4 v25, s[36:39], 0 offen sc1 lds
    s_add_u32 m0, s48, 2048
    v_bfe_u32 v70, v68, 1, 3
    buffer_load_dwordx4 v26, s[36:39], 0 offen sc1 lds
    s_add_u32 m0, s48, 3072
    v_xor_b32 v70, v70, v240
    buffer_load_dwordx4 v27, s[36:39], 0 offen sc1 lds
    v_lshl_add_u32 v69, v70, 4, v69
    v_add_u32 v69, 77824, v69
    ds_read_b128 v[36:39], v69
    v_xor_b32 v69, 32, v69
    ds_read_b128 v[40:43], v69
    v_xor_b32 v69, 96, v69
    ds_read_b128 v[44:47], v69
    v_xor_b32 v69, 32, v69
    ds_read_b128 v[48:51], v69
    s_waitcnt lgkmcnt(4)
    v_cmp_le_u32 vcc, s15, v8
    v_xor_b32 v236, v8, v9
    s_not_b64 s[60:61], vcc
    s_mov_b64 exec, vcc
    buffer_load_dwordx4 v[52:55], v[8:9], s[20:23], 0 idxen offen
    s_mov_b64 exec, -1
    s_mov_b64 exec, s[60:61]
    ds_read_b128 v[52:55], v236
    s_mov_b64 exec, -1
    v_xor_b32 v236, v10, v9
    ds_read_b128 v[56:59], v236
    v_mov_b32 v232, v124
    v_mov_b32 v233, v125
    v_mov_b32 v234, v126
    s_waitcnt lgkmcnt(2)
    v_mfma_f32_32x32x16_bf16 v[100:115], v[132:135], v[36:39], 0
    s_lshl_b32 s49, s41, 7
    s_add_u32 s49, s49, 94208
    s_movk_i32 s50, 0x3fc
    s_movk_i32 s75, 0x3f8
    v_mfma_f32_32x32x16_bf16 v[100:115], v[140:143], v[40:43], v[100:115]
    v_mov_b32 v216, v233
    v_lshrrev_b32 v212, 24, v232
    v_mul_u32_u24 v212, 272, v212
    v_lshl_add_u32 v212, v9, 1, v212
    v_mfma_f32_32x32x16_bf16 v[100:115], v[148:151], v[44:47], v[100:115]
    v_add_u32 v212, s49, v212
    v_mov_b32 v219, 1536
    v_cmp_gt_u32 s[56:57], s50, v216
    v_cmp_gt_u32 s[58:59], s75, v216
    v_mfma_f32_32x32x16_bf16 v[100:115], v[156:159], v[48:51], v[100:115]
    v_add_u32 v213, 272, v212
    v_add_u32 v214, 544, v212
    v_add_u32 v215, 816, v212
    v_cmp_gt_u32 vcc, 0x400, v216
    v_mfma_f32_32x32x16_bf16 v[116:131], v[136:139], v[36:39], 0
    v_cndmask_b32 v213, v219, v213, s[56:57]
    v_cndmask_b32 v214, v219, v214, s[58:59]
    v_cndmask_b32 v212, v219, v212, vcc
    v_cmp_gt_u32 vcc, s70, v234
    v_mfma_f32_32x32x16_bf16 v[116:131], v[144:147], v[40:43], v[116:131]
    v_lshlrev_b32 v217, 7, v234
    v_lshl_add_u32 v217, v9, 1, v217
    s_lshl_b32 s49, s40, 11
    v_cndmask_b32 v217, v243, v217, vcc
    v_mfma_f32_32x32x16_bf16 v[116:131], v[152:155], v[44:47], v[116:131]
    v_add_u32 v218, s49, v238
    v_mul_u32_u24 v219, 272, v239
    v_add3_u32 v219, v219, v9, s48
    v_and_or_b32 v24, v72, s13, v20
    v_mfma_f32_32x32x16_bf16 v[116:131], v[160:163], v[48:51], v[116:131]
    v_and_or_b32 v25, v73, s13, v21
    v_and_or_b32 v26, v74, s13, v22
    v_and_or_b32 v27, v75, s13, v23
    s_mov_b32 s74, 0xbfb8aa3b
    s_mov_b32 s75, 0xbfb8aa3b
    s_waitcnt vmcnt(0)
    ds_read_b128 v[36:39], v16
    ds_read_b128 v[40:43], v17
    ds_read_b128 v[44:47], v18
    ds_read_b128 v[48:51], v19
    v_pk_mul_f32 v[100:101], v[100:101], s[74:75]
    v_pk_mul_f32 v[102:103], v[102:103], s[74:75]
    v_pk_mul_f32 v[104:105], v[104:105], s[74:75]
    v_pk_mul_f32 v[106:107], v[106:107], s[74:75]
    v_pk_mul_f32 v[108:109], v[108:109], s[74:75]
    v_pk_mul_f32 v[110:111], v[110:111], s[74:75]
    v_pk_mul_f32 v[112:113], v[112:113], s[74:75]
    v_pk_mul_f32 v[114:115], v[114:115], s[74:75]
    v_pk_mul_f32 v[116:117], v[116:117], s[74:75]
    v_pk_mul_f32 v[118:119], v[118:119], s[74:75]
    v_pk_mul_f32 v[120:121], v[120:121], s[74:75]
    v_pk_mul_f32 v[122:123], v[122:123], s[74:75]
    v_pk_mul_f32 v[124:125], v[124:125], s[74:75]
    v_pk_mul_f32 v[126:127], v[126:127], s[74:75]
    v_pk_mul_f32 v[128:129], v[128:129], s[74:75]
    v_pk_mul_f32 v[130:131], v[130:131], s[74:75]
    s_waitcnt lgkmcnt(0)
    v_mfma_f32_32x32x16_bf16 v[68:83], v[172:175], v[52:55], v[100:115]
    s_add_u32 m0, s48, 0
    s_nop 0
    buffer_load_dwordx4 v24, s[36:39], 0 offen sc1 lds
    s_add_u32 m0, s48, 1024
    s_nop 0
    buffer_load_dwordx4 v25, s[36:39], 0 offen sc1 lds
    s_add_u32 m0, s48, 2048
    s_nop 0
    buffer_load_dwordx4 v26, s[36:39], 0 offen sc1 lds
    s_add_u32 m0, s48, 3072
    s_nop 0
    buffer_load_dwordx4 v27, s[36:39], 0 offen sc1 lds
    v_cmp_le_u32 vcc, s15, v10
    v_smfmac_f32_32x32x32_bf16 v[68:83], v[164:167], v[36:43], v168
    s_mov_b64 exec, vcc
    buffer_load_dwordx4 v[56:59], v[10:11], s[20:23], 0 idxen offen
    s_mov_b64 exec, -1
    v_and_or_b32 v24, v228, s13, v20
    v_and_or_b32 v25, v229, s13, v21
    v_and_or_b32 v26, v230, s13, v22
    v_and_or_b32 v27, v231, s13, v23
    s_nop 7
    s_nop 3
    s_setprio 1
    v_mfma_f32_32x32x16_bf16 v[84:99], v[176:179], v[52:55], v[116:131]
    v_exp_f32 v28, v68
    v_and_or_b32 v4, v8, s14, 1.0
    v_exp_f32 v29, v69
    ds_read_b32 v8, v2 offset:21504
    v_exp_f32 v30, v70
    v_exp_f32 v31, v71
    v_exp_f32 v32, v72
    v_exp_f32 v33, v73
    v_exp_f32 v34, v74
    v_exp_f32 v35, v75
    v_pk_add_f32 v[28:29], v[28:29], v[4:5] op_sel_hi:[1,0]
    v_pk_add_f32 v[30:31], v[30:31], v[4:5] op_sel_hi:[1,0]
    v_pk_add_f32 v[32:33], v[32:33], v[4:5] op_sel_hi:[1,0]
    v_pk_add_f32 v[34:35], v[34:35], v[4:5] op_sel_hi:[1,0]
    v_smfmac_f32_32x32x32_bf16 v[84:99], v[164:167], v[44:51], v168
    v_rcp_f32 v28, v28
    v_rcp_f32 v29, v29
    v_rcp_f32 v30, v30
    s_waitcnt lgkmcnt(0)
    v_xor_b32 v236, v8, v9
    v_rcp_f32 v31, v31
    ds_read_b128 v[52:55], v236
    v_rcp_f32 v32, v32
    v_rcp_f32 v33, v33
    v_rcp_f32 v34, v34
    v_rcp_f32 v35, v35
    v_pk_mul_f32 v[132:133], v[68:69], v[28:29]
    v_pk_mul_f32 v[134:135], v[70:71], v[30:31]
    v_pk_mul_f32 v[136:137], v[72:73], v[32:33]
    v_pk_mul_f32 v[138:139], v[74:75], v[34:35]
    v_exp_f32 v28, v76
    s_waitcnt vmcnt(1)
    v_exp_f32 v29, v77
    ds_read_b128 v[36:39], v16
    v_exp_f32 v30, v78
    ds_read_b128 v[40:43], v17
    v_exp_f32 v31, v79
    ds_read_b128 v[44:47], v18
    v_exp_f32 v32, v80
    ds_read_b128 v[48:51], v19
    v_exp_f32 v33, v81
    v_exp_f32 v34, v82
    v_exp_f32 v35, v83
    s_add_u32 m0, s48, 0
    v_pk_add_f32 v[28:29], v[28:29], v[4:5] op_sel_hi:[1,0]
    v_pk_add_f32 v[30:31], v[30:31], v[4:5] op_sel_hi:[1,0]
    v_pk_add_f32 v[32:33], v[32:33], v[4:5] op_sel_hi:[1,0]
    v_pk_add_f32 v[34:35], v[34:35], v[4:5] op_sel_hi:[1,0]
    v_rcp_f32 v28, v28
    s_waitcnt lgkmcnt(0)
    buffer_load_dwordx4 v24, s[36:39], 0 offen sc1 lds
    v_rcp_f32 v29, v29
    s_add_u32 m0, s48, 1024
    v_rcp_f32 v30, v30
    buffer_load_dwordx4 v25, s[36:39], 0 offen sc1 lds
    v_rcp_f32 v31, v31
    s_add_u32 m0, s48, 2048
    v_rcp_f32 v32, v32
    buffer_load_dwordx4 v26, s[36:39], 0 offen sc1 lds
    v_rcp_f32 v33, v33
    s_add_u32 m0, s48, 3072
    v_rcp_f32 v34, v34
    buffer_load_dwordx4 v27, s[36:39], 0 offen sc1 lds
    v_rcp_f32 v35, v35
    v_pk_mul_f32 v[140:141], v[76:77], v[28:29]
    v_pk_mul_f32 v[142:143], v[78:79], v[30:31]
    v_pk_mul_f32 v[144:145], v[80:81], v[32:33]
    v_pk_mul_f32 v[146:147], v[82:83], v[34:35]
    s_setprio 0
    s_waitcnt vmcnt(4) lgkmcnt(0)
    v_mfma_f32_32x32x16_bf16 v[68:83], v[172:175], v[56:59], v[100:115]
    v_exp_f32 v28, v84
    v_exp_f32 v29, v85
    v_exp_f32 v30, v86
    v_exp_f32 v31, v87
    v_exp_f32 v32, v88
    ds_read_b128 v[24:27], v1 offset:5120
    v_exp_f32 v33, v89
    v_exp_f32 v34, v90
    v_exp_f32 v35, v91
    v_pk_add_f32 v[28:29], v[28:29], v[4:5] op_sel_hi:[1,0]
    v_pk_add_f32 v[30:31], v[30:31], v[4:5] op_sel_hi:[1,0]
    v_pk_add_f32 v[32:33], v[32:33], v[4:5] op_sel_hi:[1,0]
    v_pk_add_f32 v[34:35], v[34:35], v[4:5] op_sel_hi:[1,0]
    v_smfmac_f32_32x32x32_bf16 v[68:83], v[164:167], v[36:43], v168
    v_rcp_f32 v28, v28
    v_rcp_f32 v29, v29
    v_rcp_f32 v30, v30
    v_rcp_f32 v31, v31
    v_cmp_le_u32 vcc, s15, v8
    v_rcp_f32 v32, v32
    s_mov_b64 exec, vcc
    buffer_load_dwordx4 v[52:55], v[8:9], s[20:23], 0 idxen offen
    s_mov_b64 exec, -1
    v_rcp_f32 v33, v33
    v_rcp_f32 v34, v34
    v_rcp_f32 v35, v35
    v_pk_mul_f32 v[148:149], v[84:85], v[28:29]
    v_pk_mul_f32 v[150:151], v[86:87], v[30:31]
    v_pk_mul_f32 v[152:153], v[88:89], v[32:33]
    v_pk_mul_f32 v[154:155], v[90:91], v[34:35]
    v_exp_f32 v28, v92
    v_exp_f32 v29, v93
    v_exp_f32 v30, v94
    v_exp_f32 v31, v95
    v_exp_f32 v32, v96
    s_waitcnt lgkmcnt(0)
    v_and_or_b32 v24, v24, s13, v20
    v_exp_f32 v33, v97
    v_and_or_b32 v25, v25, s13, v21
    v_exp_f32 v34, v98
    v_and_or_b32 v26, v26, s13, v22
    v_exp_f32 v35, v99
    v_and_or_b32 v27, v27, s13, v23
    v_pk_add_f32 v[28:29], v[28:29], v[4:5] op_sel_hi:[1,0]
    v_pk_add_f32 v[30:31], v[30:31], v[4:5] op_sel_hi:[1,0]
    v_pk_add_f32 v[32:33], v[32:33], v[4:5] op_sel_hi:[1,0]
    v_pk_add_f32 v[34:35], v[34:35], v[4:5] op_sel_hi:[1,0]
    v_rcp_f32 v28, v28
    v_rcp_f32 v29, v29
    v_rcp_f32 v30, v30
    v_rcp_f32 v31, v31
    v_rcp_f32 v32, v32
    v_rcp_f32 v33, v33
    v_rcp_f32 v34, v34
    v_rcp_f32 v35, v35
    s_cmp_eq_u32 s47, 1
    v_pk_mul_f32 v[156:157], v[92:93], v[28:29]
    v_pk_mul_f32 v[158:159], v[94:95], v[30:31]
    v_pk_mul_f32 v[160:161], v[96:97], v[32:33]
    v_pk_mul_f32 v[162:163], v[98:99], v[34:35]
    s_cbranch_scc1 M_FLUSH
    s_setprio 1
    v_mfma_f32_32x32x16_bf16 v[84:99], v[176:179], v[56:59], v[116:131]
    v_exp_f32 v28, v68
    v_and_or_b32 v4, v10, s14, 1.0
    v_exp_f32 v29, v69
    ds_read_b32 v10, v2 offset:22528
    v_exp_f32 v30, v70
    v_exp_f32 v31, v71
    v_exp_f32 v32, v72
    v_exp_f32 v33, v73
    v_exp_f32 v34, v74
    v_exp_f32 v35, v75
    v_pk_add_f32 v[28:29], v[28:29], v[4:5] op_sel_hi:[1,0]
    v_pk_add_f32 v[30:31], v[30:31], v[4:5] op_sel_hi:[1,0]
    v_pk_add_f32 v[32:33], v[32:33], v[4:5] op_sel_hi:[1,0]
    v_pk_add_f32 v[34:35], v[34:35], v[4:5] op_sel_hi:[1,0]
    v_smfmac_f32_32x32x32_bf16 v[84:99], v[164:167], v[44:51], v168
    v_rcp_f32 v28, v28
    v_rcp_f32 v29, v29
    v_rcp_f32 v30, v30
    s_waitcnt lgkmcnt(0)
    v_xor_b32 v236, v10, v9
    v_rcp_f32 v31, v31
    ds_read_b128 v[56:59], v236
    v_rcp_f32 v32, v32
    v_rcp_f32 v33, v33
    v_rcp_f32 v34, v34
    v_rcp_f32 v35, v35
    v_pk_fma_f32 v[132:133], v[68:69], v[28:29], v[132:133]
    v_pk_fma_f32 v[134:135], v[70:71], v[30:31], v[134:135]
    v_pk_fma_f32 v[136:137], v[72:73], v[32:33], v[136:137]
    v_pk_fma_f32 v[138:139], v[74:75], v[34:35], v[138:139]
    v_exp_f32 v28, v76
    s_waitcnt vmcnt(1)
    v_exp_f32 v29, v77
    ds_read_b128 v[36:39], v16
    v_exp_f32 v30, v78
    ds_read_b128 v[40:43], v17
    v_exp_f32 v31, v79
    ds_read_b128 v[44:47], v18
    v_exp_f32 v32, v80
    ds_read_b128 v[48:51], v19
    v_exp_f32 v33, v81
    v_exp_f32 v34, v82
    v_exp_f32 v35, v83
    s_add_u32 m0, s48, 0
    v_pk_add_f32 v[28:29], v[28:29], v[4:5] op_sel_hi:[1,0]
    v_pk_add_f32 v[30:31], v[30:31], v[4:5] op_sel_hi:[1,0]
    v_pk_add_f32 v[32:33], v[32:33], v[4:5] op_sel_hi:[1,0]
    v_pk_add_f32 v[34:35], v[34:35], v[4:5] op_sel_hi:[1,0]
    v_rcp_f32 v28, v28
    s_waitcnt lgkmcnt(0)
    buffer_load_dwordx4 v24, s[36:39], 0 offen sc1 lds
    v_rcp_f32 v29, v29
    s_add_u32 m0, s48, 1024
    v_rcp_f32 v30, v30
    buffer_load_dwordx4 v25, s[36:39], 0 offen sc1 lds
    v_rcp_f32 v31, v31
    s_add_u32 m0, s48, 2048
    v_rcp_f32 v32, v32
    buffer_load_dwordx4 v26, s[36:39], 0 offen sc1 lds
    v_rcp_f32 v33, v33
    s_add_u32 m0, s48, 3072
    v_rcp_f32 v34, v34
    buffer_load_dwordx4 v27, s[36:39], 0 offen sc1 lds
    v_rcp_f32 v35, v35
    v_pk_fma_f32 v[140:141], v[76:77], v[28:29], v[140:141]
    v_pk_fma_f32 v[142:143], v[78:79], v[30:31], v[142:143]
    v_pk_fma_f32 v[144:145], v[80:81], v[32:33], v[144:145]
    v_pk_fma_f32 v[146:147], v[82:83], v[34:35], v[146:147]
    s_setprio 0
    s_waitcnt vmcnt(4) lgkmcnt(0)
    v_mfma_f32_32x32x16_bf16 v[68:83], v[172:175], v[52:55], v[100:115]
    v_exp_f32 v28, v84
    v_exp_f32 v29, v85
    v_exp_f32 v30, v86
    v_exp_f32 v31, v87
    v_exp_f32 v32, v88
    ds_read_b128 v[24:27], v1 offset:6144
    v_exp_f32 v33, v89
    v_exp_f32 v34, v90
    v_exp_f32 v35, v91
    v_pk_add_f32 v[28:29], v[28:29], v[4:5] op_sel_hi:[1,0]
    v_pk_add_f32 v[30:31], v[30:31], v[4:5] op_sel_hi:[1,0]
    v_pk_add_f32 v[32:33], v[32:33], v[4:5] op_sel_hi:[1,0]
    v_pk_add_f32 v[34:35], v[34:35], v[4:5] op_sel_hi:[1,0]
    v_smfmac_f32_32x32x32_bf16 v[68:83], v[164:167], v[36:43], v168
    v_rcp_f32 v28, v28
    v_rcp_f32 v29, v29
    v_rcp_f32 v30, v30
    v_rcp_f32 v31, v31
    v_cmp_le_u32 vcc, s15, v10
    v_rcp_f32 v32, v32
    s_mov_b64 exec, vcc
    buffer_load_dwordx4 v[56:59], v[10:11], s[20:23], 0 idxen offen
    s_mov_b64 exec, -1
    v_rcp_f32 v33, v33
    v_rcp_f32 v34, v34
    v_rcp_f32 v35, v35
    v_pk_fma_f32 v[148:149], v[84:85], v[28:29], v[148:149]
    v_pk_fma_f32 v[150:151], v[86:87], v[30:31], v[150:151]
    v_pk_fma_f32 v[152:153], v[88:89], v[32:33], v[152:153]
    v_pk_fma_f32 v[154:155], v[90:91], v[34:35], v[154:155]
    v_exp_f32 v28, v92
    v_exp_f32 v29, v93
    v_exp_f32 v30, v94
    v_exp_f32 v31, v95
    v_exp_f32 v32, v96
    s_waitcnt lgkmcnt(0)
    v_and_or_b32 v24, v24, s13, v20
    v_exp_f32 v33, v97
    v_and_or_b32 v25, v25, s13, v21
    v_exp_f32 v34, v98
    v_and_or_b32 v26, v26, s13, v22
    v_exp_f32 v35, v99
    v_and_or_b32 v27, v27, s13, v23
    v_pk_add_f32 v[28:29], v[28:29], v[4:5] op_sel_hi:[1,0]
    v_pk_add_f32 v[30:31], v[30:31], v[4:5] op_sel_hi:[1,0]
    v_pk_add_f32 v[32:33], v[32:33], v[4:5] op_sel_hi:[1,0]
    v_pk_add_f32 v[34:35], v[34:35], v[4:5] op_sel_hi:[1,0]
    v_rcp_f32 v28, v28
    v_rcp_f32 v29, v29
    v_rcp_f32 v30, v30
    v_rcp_f32 v31, v31
    v_rcp_f32 v32, v32
    v_rcp_f32 v33, v33
    v_rcp_f32 v34, v34
    v_rcp_f32 v35, v35
    s_cmp_eq_u32 s47, 2
    v_pk_fma_f32 v[156:157], v[92:93], v[28:29], v[156:157]
    v_pk_fma_f32 v[158:159], v[94:95], v[30:31], v[158:159]
    v_pk_fma_f32 v[160:161], v[96:97], v[32:33], v[160:161]
    v_pk_fma_f32 v[162:163], v[98:99], v[34:35], v[162:163]
    s_cbranch_scc1 M_FLUSH
    s_setprio 1
    v_mfma_f32_32x32x16_bf16 v[84:99], v[176:179], v[52:55], v[116:131]
    v_exp_f32 v28, v68
    v_and_or_b32 v4, v8, s14, 1.0
    v_exp_f32 v29, v69
    ds_read_b32 v8, v2 offset:23552
    v_exp_f32 v30, v70
    v_exp_f32 v31, v71
    v_exp_f32 v32, v72
    v_exp_f32 v33, v73
    v_exp_f32 v34, v74
    v_exp_f32 v35, v75
    v_pk_add_f32 v[28:29], v[28:29], v[4:5] op_sel_hi:[1,0]
    v_pk_add_f32 v[30:31], v[30:31], v[4:5] op_sel_hi:[1,0]
    v_pk_add_f32 v[32:33], v[32:33], v[4:5] op_sel_hi:[1,0]
    v_pk_add_f32 v[34:35], v[34:35], v[4:5] op_sel_hi:[1,0]
    v_smfmac_f32_32x32x32_bf16 v[84:99], v[164:167], v[44:51], v168
    v_rcp_f32 v28, v28
    v_rcp_f32 v29, v29
    v_rcp_f32 v30, v30
    s_waitcnt lgkmcnt(0)
    v_xor_b32 v236, v8, v9
    v_rcp_f32 v31, v31
    ds_read_b128 v[52:55], v236
    v_rcp_f32 v32, v32
    v_rcp_f32 v33, v33
    v_rcp_f32 v34, v34
    v_rcp_f32 v35, v35
    v_pk_fma_f32 v[132:133], v[68:69], v[28:29], v[132:133]
    v_pk_fma_f32 v[134:135], v[70:71], v[30:31], v[134:135]
    v_pk_fma_f32 v[136:137], v[72:73], v[32:33], v[136:137]
    v_pk_fma_f32 v[138:139], v[74:75], v[34:35], v[138:139]
    v_exp_f32 v28, v76
    s_waitcnt vmcnt(1)
    v_exp_f32 v29, v77
    ds_read_b128 v[36:39], v16
    v_exp_f32 v30, v78
    ds_read_b128 v[40:43], v17
    v_exp_f32 v31, v79
    ds_read_b128 v[44:47], v18
    v_exp_f32 v32, v80
    ds_read_b128 v[48:51], v19
    v_exp_f32 v33, v81
    v_exp_f32 v34, v82
    v_exp_f32 v35, v83
    s_add_u32 m0, s48, 0
    v_pk_add_f32 v[28:29], v[28:29], v[4:5] op_sel_hi:[1,0]
    v_pk_add_f32 v[30:31], v[30:31], v[4:5] op_sel_hi:[1,0]
    v_pk_add_f32 v[32:33], v[32:33], v[4:5] op_sel_hi:[1,0]
    v_pk_add_f32 v[34:35], v[34:35], v[4:5] op_sel_hi:[1,0]
    v_rcp_f32 v28, v28
    s_waitcnt lgkmcnt(0)
    buffer_load_dwordx4 v24, s[36:39], 0 offen sc1 lds
    v_rcp_f32 v29, v29
    s_add_u32 m0, s48, 1024
    v_rcp_f32 v30, v30
    buffer_load_dwordx4 v25, s[36:39], 0 offen sc1 lds
    v_rcp_f32 v31, v31
    s_add_u32 m0, s48, 2048
    v_rcp_f32 v32, v32
    buffer_load_dwordx4 v26, s[36:39], 0 offen sc1 lds
    v_rcp_f32 v33, v33
    s_add_u32 m0, s48, 3072
    v_rcp_f32 v34, v34
    buffer_load_dwordx4 v27, s[36:39], 0 offen sc1 lds
    v_rcp_f32 v35, v35
    v_pk_fma_f32 v[140:141], v[76:77], v[28:29], v[140:141]
    v_pk_fma_f32 v[142:143], v[78:79], v[30:31], v[142:143]
    v_pk_fma_f32 v[144:145], v[80:81], v[32:33], v[144:145]
    v_pk_fma_f32 v[146:147], v[82:83], v[34:35], v[146:147]
    s_setprio 0
    s_waitcnt vmcnt(4) lgkmcnt(0)
    v_mfma_f32_32x32x16_bf16 v[68:83], v[172:175], v[56:59], v[100:115]
    v_exp_f32 v28, v84
    v_exp_f32 v29, v85
    v_exp_f32 v30, v86
    v_exp_f32 v31, v87
    v_exp_f32 v32, v88
    ds_read_b128 v[24:27], v1 offset:7168
    v_exp_f32 v33, v89
    v_exp_f32 v34, v90
    v_exp_f32 v35, v91
    v_pk_add_f32 v[28:29], v[28:29], v[4:5] op_sel_hi:[1,0]
    v_pk_add_f32 v[30:31], v[30:31], v[4:5] op_sel_hi:[1,0]
    v_pk_add_f32 v[32:33], v[32:33], v[4:5] op_sel_hi:[1,0]
    v_pk_add_f32 v[34:35], v[34:35], v[4:5] op_sel_hi:[1,0]
    v_smfmac_f32_32x32x32_bf16 v[68:83], v[164:167], v[36:43], v168
    v_rcp_f32 v28, v28
    v_rcp_f32 v29, v29
    v_rcp_f32 v30, v30
    v_rcp_f32 v31, v31
    v_cmp_le_u32 vcc, s15, v8
    v_rcp_f32 v32, v32
    s_mov_b64 exec, vcc
    buffer_load_dwordx4 v[52:55], v[8:9], s[20:23], 0 idxen offen
    s_mov_b64 exec, -1
    v_rcp_f32 v33, v33
    v_rcp_f32 v34, v34
    v_rcp_f32 v35, v35
    v_pk_fma_f32 v[148:149], v[84:85], v[28:29], v[148:149]
    v_pk_fma_f32 v[150:151], v[86:87], v[30:31], v[150:151]
    v_pk_fma_f32 v[152:153], v[88:89], v[32:33], v[152:153]
    v_pk_fma_f32 v[154:155], v[90:91], v[34:35], v[154:155]
    v_exp_f32 v28, v92
    v_exp_f32 v29, v93
    v_exp_f32 v30, v94
    v_exp_f32 v31, v95
    v_exp_f32 v32, v96
    s_waitcnt lgkmcnt(0)
    v_and_or_b32 v24, v24, s13, v20
    v_exp_f32 v33, v97
    v_and_or_b32 v25, v25, s13, v21
    v_exp_f32 v34, v98
    v_and_or_b32 v26, v26, s13, v22
    v_exp_f32 v35, v99
    v_and_or_b32 v27, v27, s13, v23
    v_pk_add_f32 v[28:29], v[28:29], v[4:5] op_sel_hi:[1,0]
    v_pk_add_f32 v[30:31], v[30:31], v[4:5] op_sel_hi:[1,0]
    v_pk_add_f32 v[32:33], v[32:33], v[4:5] op_sel_hi:[1,0]
    v_pk_add_f32 v[34:35], v[34:35], v[4:5] op_sel_hi:[1,0]
    v_rcp_f32 v28, v28
    v_rcp_f32 v29, v29
    v_rcp_f32 v30, v30
    v_rcp_f32 v31, v31
    v_rcp_f32 v32, v32
    v_rcp_f32 v33, v33
    v_rcp_f32 v34, v34
    v_rcp_f32 v35, v35
    s_cmp_eq_u32 s47, 3
    v_pk_fma_f32 v[156:157], v[92:93], v[28:29], v[156:157]
    v_pk_fma_f32 v[158:159], v[94:95], v[30:31], v[158:159]
    v_pk_fma_f32 v[160:161], v[96:97], v[32:33], v[160:161]
    v_pk_fma_f32 v[162:163], v[98:99], v[34:35], v[162:163]
    s_cbranch_scc1 M_FLUSH
    s_setprio 1
    v_mfma_f32_32x32x16_bf16 v[84:99], v[176:179], v[56:59], v[116:131]
    v_exp_f32 v28, v68
    v_and_or_b32 v4, v10, s14, 1.0
    v_exp_f32 v29, v69
    ds_read_b32 v10, v2 offset:24576
    v_exp_f32 v30, v70
    v_exp_f32 v31, v71
    v_exp_f32 v32, v72
    v_exp_f32 v33, v73
    v_exp_f32 v34, v74
    v_exp_f32 v35, v75
    v_pk_add_f32 v[28:29], v[28:29], v[4:5] op_sel_hi:[1,0]
    v_pk_add_f32 v[30:31], v[30:31], v[4:5] op_sel_hi:[1,0]
    v_pk_add_f32 v[32:33], v[32:33], v[4:5] op_sel_hi:[1,0]
    v_pk_add_f32 v[34:35], v[34:35], v[4:5] op_sel_hi:[1,0]
    v_smfmac_f32_32x32x32_bf16 v[84:99], v[164:167], v[44:51], v168
    v_rcp_f32 v28, v28
    v_rcp_f32 v29, v29
    v_rcp_f32 v30, v30
    s_waitcnt lgkmcnt(0)
    v_xor_b32 v236, v10, v9
    v_rcp_f32 v31, v31
    ds_read_b128 v[56:59], v236
    v_rcp_f32 v32, v32
    v_rcp_f32 v33, v33
    v_rcp_f32 v34, v34
    v_rcp_f32 v35, v35
    v_pk_fma_f32 v[132:133], v[68:69], v[28:29], v[132:133]
    v_pk_fma_f32 v[134:135], v[70:71], v[30:31], v[134:135]
    v_pk_fma_f32 v[136:137], v[72:73], v[32:33], v[136:137]
    v_pk_fma_f32 v[138:139], v[74:75], v[34:35], v[138:139]
    v_exp_f32 v28, v76
    s_waitcnt vmcnt(1)
    v_exp_f32 v29, v77
    ds_read_b128 v[36:39], v16
    v_exp_f32 v30, v78
    ds_read_b128 v[40:43], v17
    v_exp_f32 v31, v79
    ds_read_b128 v[44:47], v18
    v_exp_f32 v32, v80
    ds_read_b128 v[48:51], v19
    v_exp_f32 v33, v81
    v_exp_f32 v34, v82
    v_exp_f32 v35, v83
    s_add_u32 m0, s48, 0
    v_pk_add_f32 v[28:29], v[28:29], v[4:5] op_sel_hi:[1,0]
    v_pk_add_f32 v[30:31], v[30:31], v[4:5] op_sel_hi:[1,0]
    v_pk_add_f32 v[32:33], v[32:33], v[4:5] op_sel_hi:[1,0]
    v_pk_add_f32 v[34:35], v[34:35], v[4:5] op_sel_hi:[1,0]
    v_rcp_f32 v28, v28
    s_waitcnt lgkmcnt(0)
    buffer_load_dwordx4 v24, s[36:39], 0 offen sc1 lds
    v_rcp_f32 v29, v29
    s_add_u32 m0, s48, 1024
    v_rcp_f32 v30, v30
    buffer_load_dwordx4 v25, s[36:39], 0 offen sc1 lds
    v_rcp_f32 v31, v31
    s_add_u32 m0, s48, 2048
    v_rcp_f32 v32, v32
    buffer_load_dwordx4 v26, s[36:39], 0 offen sc1 lds
    v_rcp_f32 v33, v33
    s_add_u32 m0, s48, 3072
    v_rcp_f32 v34, v34
    buffer_load_dwordx4 v27, s[36:39], 0 offen sc1 lds
    v_rcp_f32 v35, v35
    v_pk_fma_f32 v[140:141], v[76:77], v[28:29], v[140:141]
    v_pk_fma_f32 v[142:143], v[78:79], v[30:31], v[142:143]
    v_pk_fma_f32 v[144:145], v[80:81], v[32:33], v[144:145]
    v_pk_fma_f32 v[146:147], v[82:83], v[34:35], v[146:147]
    s_setprio 0
    s_waitcnt vmcnt(4) lgkmcnt(0)
    v_mfma_f32_32x32x16_bf16 v[68:83], v[172:175], v[52:55], v[100:115]
    v_exp_f32 v28, v84
    v_exp_f32 v29, v85
    v_exp_f32 v30, v86
    v_exp_f32 v31, v87
    v_exp_f32 v32, v88
    ds_read_b128 v[24:27], v1 offset:8192
    v_exp_f32 v33, v89
    v_exp_f32 v34, v90
    v_exp_f32 v35, v91
    v_pk_add_f32 v[28:29], v[28:29], v[4:5] op_sel_hi:[1,0]
    v_pk_add_f32 v[30:31], v[30:31], v[4:5] op_sel_hi:[1,0]
    v_pk_add_f32 v[32:33], v[32:33], v[4:5] op_sel_hi:[1,0]
    v_pk_add_f32 v[34:35], v[34:35], v[4:5] op_sel_hi:[1,0]
    v_smfmac_f32_32x32x32_bf16 v[68:83], v[164:167], v[36:43], v168
    v_rcp_f32 v28, v28
    v_rcp_f32 v29, v29
    v_rcp_f32 v30, v30
    v_rcp_f32 v31, v31
    v_cmp_le_u32 vcc, s15, v10
    v_rcp_f32 v32, v32
    s_mov_b64 exec, vcc
    buffer_load_dwordx4 v[56:59], v[10:11], s[20:23], 0 idxen offen
    s_mov_b64 exec, -1
    v_rcp_f32 v33, v33
    v_rcp_f32 v34, v34
    v_rcp_f32 v35, v35
    v_pk_fma_f32 v[148:149], v[84:85], v[28:29], v[148:149]
    v_pk_fma_f32 v[150:151], v[86:87], v[30:31], v[150:151]
    v_pk_fma_f32 v[152:153], v[88:89], v[32:33], v[152:153]
    v_pk_fma_f32 v[154:155], v[90:91], v[34:35], v[154:155]
    v_exp_f32 v28, v92
    v_exp_f32 v29, v93
    v_exp_f32 v30, v94
    v_exp_f32 v31, v95
    v_exp_f32 v32, v96
    s_waitcnt lgkmcnt(0)
    v_and_or_b32 v24, v24, s13, v20
    v_exp_f32 v33, v97
    v_and_or_b32 v25, v25, s13, v21
    v_exp_f32 v34, v98
    v_and_or_b32 v26, v26, s13, v22
    v_exp_f32 v35, v99
    v_and_or_b32 v27, v27, s13, v23
    v_pk_add_f32 v[28:29], v[28:29], v[4:5] op_sel_hi:[1,0]
    v_pk_add_f32 v[30:31], v[30:31], v[4:5] op_sel_hi:[1,0]
    v_pk_add_f32 v[32:33], v[32:33], v[4:5] op_sel_hi:[1,0]
    v_pk_add_f32 v[34:35], v[34:35], v[4:5] op_sel_hi:[1,0]
    v_rcp_f32 v28, v28
    v_rcp_f32 v29, v29
    v_rcp_f32 v30, v30
    v_rcp_f32 v31, v31
    v_rcp_f32 v32, v32
    v_rcp_f32 v33, v33
    v_rcp_f32 v34, v34
    v_rcp_f32 v35, v35
    s_cmp_eq_u32 s47, 4
    v_pk_fma_f32 v[156:157], v[92:93], v[28:29], v[156:157]
    v_pk_fma_f32 v[158:159], v[94:95], v[30:31], v[158:159]
    v_pk_fma_f32 v[160:161], v[96:97], v[32:33], v[160:161]
    v_pk_fma_f32 v[162:163], v[98:99], v[34:35], v[162:163]
    s_cbranch_scc1 M_FLUSH
    s_setprio 1
    v_mfma_f32_32x32x16_bf16 v[84:99], v[176:179], v[52:55], v[116:131]
    v_exp_f32 v28, v68
    v_and_or_b32 v4, v8, s14, 1.0
    v_exp_f32 v29, v69
    ds_read_b32 v8, v2 offset:25600
    v_exp_f32 v30, v70
    v_exp_f32 v31, v71
    v_exp_f32 v32, v72
    v_exp_f32 v33, v73
    v_exp_f32 v34, v74
    v_exp_f32 v35, v75
    v_pk_add_f32 v[28:29], v[28:29], v[4:5] op_sel_hi:[1,0]
    v_pk_add_f32 v[30:31], v[30:31], v[4:5] op_sel_hi:[1,0]
    v_pk_add_f32 v[32:33], v[32:33], v[4:5] op_sel_hi:[1,0]
    v_pk_add_f32 v[34:35], v[34:35], v[4:5] op_sel_hi:[1,0]
    v_smfmac_f32_32x32x32_bf16 v[84:99], v[164:167], v[44:51], v168
    v_rcp_f32 v28, v28
    v_rcp_f32 v29, v29
    v_rcp_f32 v30, v30
    s_waitcnt lgkmcnt(0)
    v_xor_b32 v236, v8, v9
    v_rcp_f32 v31, v31
    ds_read_b128 v[52:55], v236
    v_rcp_f32 v32, v32
    v_rcp_f32 v33, v33
    v_rcp_f32 v34, v34
    v_rcp_f32 v35, v35
    v_pk_fma_f32 v[132:133], v[68:69], v[28:29], v[132:133]
    v_pk_fma_f32 v[134:135], v[70:71], v[30:31], v[134:135]
    v_pk_fma_f32 v[136:137], v[72:73], v[32:33], v[136:137]
    v_pk_fma_f32 v[138:139], v[74:75], v[34:35], v[138:139]
    v_exp_f32 v28, v76
    s_waitcnt vmcnt(1)
    v_exp_f32 v29, v77
    ds_read_b128 v[36:39], v16
    v_exp_f32 v30, v78
    ds_read_b128 v[40:43], v17
    v_exp_f32 v31, v79
    ds_read_b128 v[44:47], v18
    v_exp_f32 v32, v80
    ds_read_b128 v[48:51], v19
    v_exp_f32 v33, v81
    v_exp_f32 v34, v82
    v_exp_f32 v35, v83
    s_add_u32 m0, s48, 0
    v_pk_add_f32 v[28:29], v[28:29], v[4:5] op_sel_hi:[1,0]
    v_pk_add_f32 v[30:31], v[30:31], v[4:5] op_sel_hi:[1,0]
    v_pk_add_f32 v[32:33], v[32:33], v[4:5] op_sel_hi:[1,0]
    v_pk_add_f32 v[34:35], v[34:35], v[4:5] op_sel_hi:[1,0]
    v_rcp_f32 v28, v28
    s_waitcnt lgkmcnt(0)
    buffer_load_dwordx4 v24, s[36:39], 0 offen sc1 lds
    v_rcp_f32 v29, v29
    s_add_u32 m0, s48, 1024
    v_rcp_f32 v30, v30
    buffer_load_dwordx4 v25, s[36:39], 0 offen sc1 lds
    v_rcp_f32 v31, v31
    s_add_u32 m0, s48, 2048
    v_rcp_f32 v32, v32
    buffer_load_dwordx4 v26, s[36:39], 0 offen sc1 lds
    v_rcp_f32 v33, v33
    s_add_u32 m0, s48, 3072
    v_rcp_f32 v34, v34
    buffer_load_dwordx4 v27, s[36:39], 0 offen sc1 lds
    v_rcp_f32 v35, v35
    v_pk_fma_f32 v[140:141], v[76:77], v[28:29], v[140:141]
    v_pk_fma_f32 v[142:143], v[78:79], v[30:31], v[142:143]
    v_pk_fma_f32 v[144:145], v[80:81], v[32:33], v[144:145]
    v_pk_fma_f32 v[146:147], v[82:83], v[34:35], v[146:147]
    s_setprio 0
    s_waitcnt vmcnt(4) lgkmcnt(0)
    v_mfma_f32_32x32x16_bf16 v[68:83], v[172:175], v[56:59], v[100:115]
    v_exp_f32 v28, v84
    v_exp_f32 v29, v85
    v_exp_f32 v30, v86
    v_exp_f32 v31, v87
    v_exp_f32 v32, v88
    ds_read_b128 v[24:27], v1 offset:9216
    v_exp_f32 v33, v89
    v_exp_f32 v34, v90
    v_exp_f32 v35, v91
    v_pk_add_f32 v[28:29], v[28:29], v[4:5] op_sel_hi:[1,0]
    v_pk_add_f32 v[30:31], v[30:31], v[4:5] op_sel_hi:[1,0]
    v_pk_add_f32 v[32:33], v[32:33], v[4:5] op_sel_hi:[1,0]
    v_pk_add_f32 v[34:35], v[34:35], v[4:5] op_sel_hi:[1,0]
    v_smfmac_f32_32x32x32_bf16 v[68:83], v[164:167], v[36:43], v168
    v_rcp_f32 v28, v28
    v_rcp_f32 v29, v29
    v_rcp_f32 v30, v30
    v_rcp_f32 v31, v31
    v_cmp_le_u32 vcc, s15, v8
    v_rcp_f32 v32, v32
    s_mov_b64 exec, vcc
    buffer_load_dwordx4 v[52:55], v[8:9], s[20:23], 0 idxen offen
    s_mov_b64 exec, -1
    v_rcp_f32 v33, v33
    v_rcp_f32 v34, v34
    v_rcp_f32 v35, v35
    v_pk_fma_f32 v[148:149], v[84:85], v[28:29], v[148:149]
    v_pk_fma_f32 v[150:151], v[86:87], v[30:31], v[150:151]
    v_pk_fma_f32 v[152:153], v[88:89], v[32:33], v[152:153]
    v_pk_fma_f32 v[154:155], v[90:91], v[34:35], v[154:155]
    v_exp_f32 v28, v92
    v_exp_f32 v29, v93
    v_exp_f32 v30, v94
    v_exp_f32 v31, v95
    v_exp_f32 v32, v96
    s_waitcnt lgkmcnt(0)
    v_and_or_b32 v24, v24, s13, v20
    v_exp_f32 v33, v97
    v_and_or_b32 v25, v25, s13, v21
    v_exp_f32 v34, v98
    v_and_or_b32 v26, v26, s13, v22
    v_exp_f32 v35, v99
    v_and_or_b32 v27, v27, s13, v23
    v_pk_add_f32 v[28:29], v[28:29], v[4:5] op_sel_hi:[1,0]
    v_pk_add_f32 v[30:31], v[30:31], v[4:5] op_sel_hi:[1,0]
    v_pk_add_f32 v[32:33], v[32:33], v[4:5] op_sel_hi:[1,0]
    v_pk_add_f32 v[34:35], v[34:35], v[4:5] op_sel_hi:[1,0]
    v_rcp_f32 v28, v28
    v_rcp_f32 v29, v29
    v_rcp_f32 v30, v30
    v_rcp_f32 v31, v31
    v_rcp_f32 v32, v32
    v_rcp_f32 v33, v33
    v_rcp_f32 v34, v34
    v_rcp_f32 v35, v35
    s_cmp_eq_u32 s47, 5
    v_pk_fma_f32 v[156:157], v[92:93], v[28:29], v[156:157]
    v_pk_fma_f32 v[158:159], v[94:95], v[30:31], v[158:159]
    v_pk_fma_f32 v[160:161], v[96:97], v[32:33], v[160:161]
    v_pk_fma_f32 v[162:163], v[98:99], v[34:35], v[162:163]
    s_cbranch_scc1 M_FLUSH
    s_setprio 1
    v_mfma_f32_32x32x16_bf16 v[84:99], v[176:179], v[56:59], v[116:131]
    v_exp_f32 v28, v68
    v_and_or_b32 v4, v10, s14, 1.0
    v_exp_f32 v29, v69
    ds_read_b32 v10, v2 offset:26624
    v_exp_f32 v30, v70
    v_exp_f32 v31, v71
    v_exp_f32 v32, v72
    v_exp_f32 v33, v73
    v_exp_f32 v34, v74
    v_exp_f32 v35, v75
    v_pk_add_f32 v[28:29], v[28:29], v[4:5] op_sel_hi:[1,0]
    v_pk_add_f32 v[30:31], v[30:31], v[4:5] op_sel_hi:[1,0]
    v_pk_add_f32 v[32:33], v[32:33], v[4:5] op_sel_hi:[1,0]
    v_pk_add_f32 v[34:35], v[34:35], v[4:5] op_sel_hi:[1,0]
    v_smfmac_f32_32x32x32_bf16 v[84:99], v[164:167], v[44:51], v168
    v_rcp_f32 v28, v28
    v_rcp_f32 v29, v29
    v_rcp_f32 v30, v30
    s_waitcnt lgkmcnt(0)
    v_xor_b32 v236, v10, v9
    v_rcp_f32 v31, v31
    ds_read_b128 v[56:59], v236
    v_rcp_f32 v32, v32
    v_rcp_f32 v33, v33
    v_rcp_f32 v34, v34
    v_rcp_f32 v35, v35
    v_pk_fma_f32 v[132:133], v[68:69], v[28:29], v[132:133]
    v_pk_fma_f32 v[134:135], v[70:71], v[30:31], v[134:135]
    v_pk_fma_f32 v[136:137], v[72:73], v[32:33], v[136:137]
    v_pk_fma_f32 v[138:139], v[74:75], v[34:35], v[138:139]
    v_exp_f32 v28, v76
    s_waitcnt vmcnt(1)
    v_exp_f32 v29, v77
    ds_read_b128 v[36:39], v16
    v_exp_f32 v30, v78
    ds_read_b128 v[40:43], v17
    v_exp_f32 v31, v79
    ds_read_b128 v[44:47], v18
    v_exp_f32 v32, v80
    ds_read_b128 v[48:51], v19
    v_exp_f32 v33, v81
    v_exp_f32 v34, v82
    v_exp_f32 v35, v83
    s_add_u32 m0, s48, 0
    v_pk_add_f32 v[28:29], v[28:29], v[4:5] op_sel_hi:[1,0]
    v_pk_add_f32 v[30:31], v[30:31], v[4:5] op_sel_hi:[1,0]
    v_pk_add_f32 v[32:33], v[32:33], v[4:5] op_sel_hi:[1,0]
    v_pk_add_f32 v[34:35], v[34:35], v[4:5] op_sel_hi:[1,0]
    v_rcp_f32 v28, v28
    s_waitcnt lgkmcnt(0)
    buffer_load_dwordx4 v24, s[36:39], 0 offen sc1 lds
    v_rcp_f32 v29, v29
    s_add_u32 m0, s48, 1024
    v_rcp_f32 v30, v30
    buffer_load_dwordx4 v25, s[36:39], 0 offen sc1 lds
    v_rcp_f32 v31, v31
    s_add_u32 m0, s48, 2048
    v_rcp_f32 v32, v32
    buffer_load_dwordx4 v26, s[36:39], 0 offen sc1 lds
    v_rcp_f32 v33, v33
    s_add_u32 m0, s48, 3072
    v_rcp_f32 v34, v34
    buffer_load_dwordx4 v27, s[36:39], 0 offen sc1 lds
    v_rcp_f32 v35, v35
    v_pk_fma_f32 v[140:141], v[76:77], v[28:29], v[140:141]
    v_pk_fma_f32 v[142:143], v[78:79], v[30:31], v[142:143]
    v_pk_fma_f32 v[144:145], v[80:81], v[32:33], v[144:145]
    v_pk_fma_f32 v[146:147], v[82:83], v[34:35], v[146:147]
    s_setprio 0
    s_waitcnt vmcnt(4) lgkmcnt(0)
    v_mfma_f32_32x32x16_bf16 v[68:83], v[172:175], v[52:55], v[100:115]
    v_exp_f32 v28, v84
    v_exp_f32 v29, v85
    v_exp_f32 v30, v86
    v_exp_f32 v31, v87
    v_exp_f32 v32, v88
    ds_read_b128 v[24:27], v1 offset:10240
    v_exp_f32 v33, v89
    v_exp_f32 v34, v90
    v_exp_f32 v35, v91
    v_pk_add_f32 v[28:29], v[28:29], v[4:5] op_sel_hi:[1,0]
    v_pk_add_f32 v[30:31], v[30:31], v[4:5] op_sel_hi:[1,0]
    v_pk_add_f32 v[32:33], v[32:33], v[4:5] op_sel_hi:[1,0]
    v_pk_add_f32 v[34:35], v[34:35], v[4:5] op_sel_hi:[1,0]
    v_smfmac_f32_32x32x32_bf16 v[68:83], v[164:167], v[36:43], v168
    v_rcp_f32 v28, v28
    v_rcp_f32 v29, v29
    v_rcp_f32 v30, v30
    v_rcp_f32 v31, v31
    v_cmp_le_u32 vcc, s15, v10
    v_rcp_f32 v32, v32
    s_mov_b64 exec, vcc
    buffer_load_dwordx4 v[56:59], v[10:11], s[20:23], 0 idxen offen
    s_mov_b64 exec, -1
    v_rcp_f32 v33, v33
    v_rcp_f32 v34, v34
    v_rcp_f32 v35, v35
    v_pk_fma_f32 v[148:149], v[84:85], v[28:29], v[148:149]
    v_pk_fma_f32 v[150:151], v[86:87], v[30:31], v[150:151]
    v_pk_fma_f32 v[152:153], v[88:89], v[32:33], v[152:153]
    v_pk_fma_f32 v[154:155], v[90:91], v[34:35], v[154:155]
    v_exp_f32 v28, v92
    v_exp_f32 v29, v93
    v_exp_f32 v30, v94
    v_exp_f32 v31, v95
    v_exp_f32 v32, v96
    s_waitcnt lgkmcnt(0)
    v_and_or_b32 v24, v24, s13, v20
    v_exp_f32 v33, v97
    v_and_or_b32 v25, v25, s13, v21
    v_exp_f32 v34, v98
    v_and_or_b32 v26, v26, s13, v22
    v_exp_f32 v35, v99
    v_and_or_b32 v27, v27, s13, v23
    v_pk_add_f32 v[28:29], v[28:29], v[4:5] op_sel_hi:[1,0]
    v_pk_add_f32 v[30:31], v[30:31], v[4:5] op_sel_hi:[1,0]
    v_pk_add_f32 v[32:33], v[32:33], v[4:5] op_sel_hi:[1,0]
    v_pk_add_f32 v[34:35], v[34:35], v[4:5] op_sel_hi:[1,0]
    v_rcp_f32 v28, v28
    v_rcp_f32 v29, v29
    v_rcp_f32 v30, v30
    v_rcp_f32 v31, v31
    v_rcp_f32 v32, v32
    v_rcp_f32 v33, v33
    v_rcp_f32 v34, v34
    v_rcp_f32 v35, v35
    s_cmp_eq_u32 s47, 6
    v_pk_fma_f32 v[156:157], v[92:93], v[28:29], v[156:157]
    v_pk_fma_f32 v[158:159], v[94:95], v[30:31], v[158:159]
    v_pk_fma_f32 v[160:161], v[96:97], v[32:33], v[160:161]
    v_pk_fma_f32 v[162:163], v[98:99], v[34:35], v[162:163]
    s_cbranch_scc1 M_FLUSH
    s_setprio 1
    v_mfma_f32_32x32x16_bf16 v[84:99], v[176:179], v[52:55], v[116:131]
    v_exp_f32 v28, v68
    v_and_or_b32 v4, v8, s14, 1.0
    v_exp_f32 v29, v69
    ds_read_b32 v8, v2 offset:27648
    v_exp_f32 v30, v70
    v_exp_f32 v31, v71
    v_exp_f32 v32, v72
    v_exp_f32 v33, v73
    v_exp_f32 v34, v74
    v_exp_f32 v35, v75
    v_pk_add_f32 v[28:29], v[28:29], v[4:5] op_sel_hi:[1,0]
    v_pk_add_f32 v[30:31], v[30:31], v[4:5] op_sel_hi:[1,0]
    v_pk_add_f32 v[32:33], v[32:33], v[4:5] op_sel_hi:[1,0]
    v_pk_add_f32 v[34:35], v[34:35], v[4:5] op_sel_hi:[1,0]
    v_smfmac_f32_32x32x32_bf16 v[84:99], v[164:167], v[44:51], v168
    v_rcp_f32 v28, v28
    v_rcp_f32 v29, v29
    v_rcp_f32 v30, v30
    s_waitcnt lgkmcnt(0)
    v_xor_b32 v236, v8, v9
    v_rcp_f32 v31, v31
    ds_read_b128 v[52:55], v236
    v_rcp_f32 v32, v32
    v_rcp_f32 v33, v33
    v_rcp_f32 v34, v34
    v_rcp_f32 v35, v35
    v_pk_fma_f32 v[132:133], v[68:69], v[28:29], v[132:133]
    v_pk_fma_f32 v[134:135], v[70:71], v[30:31], v[134:135]
    v_pk_fma_f32 v[136:137], v[72:73], v[32:33], v[136:137]
    v_pk_fma_f32 v[138:139], v[74:75], v[34:35], v[138:139]
    v_exp_f32 v28, v76
    s_waitcnt vmcnt(1)
    v_exp_f32 v29, v77
    ds_read_b128 v[36:39], v16
    v_exp_f32 v30, v78
    ds_read_b128 v[40:43], v17
    v_exp_f32 v31, v79
    ds_read_b128 v[44:47], v18
    v_exp_f32 v32, v80
    ds_read_b128 v[48:51], v19
    v_exp_f32 v33, v81
    v_exp_f32 v34, v82
    v_exp_f32 v35, v83
    s_add_u32 m0, s48, 0
    v_pk_add_f32 v[28:29], v[28:29], v[4:5] op_sel_hi:[1,0]
    v_pk_add_f32 v[30:31], v[30:31], v[4:5] op_sel_hi:[1,0]
    v_pk_add_f32 v[32:33], v[32:33], v[4:5] op_sel_hi:[1,0]
    v_pk_add_f32 v[34:35], v[34:35], v[4:5] op_sel_hi:[1,0]
    v_rcp_f32 v28, v28
    s_waitcnt lgkmcnt(0)
    buffer_load_dwordx4 v24, s[36:39], 0 offen sc1 lds
    v_rcp_f32 v29, v29
    s_add_u32 m0, s48, 1024
    v_rcp_f32 v30, v30
    buffer_load_dwordx4 v25, s[36:39], 0 offen sc1 lds
    v_rcp_f32 v31, v31
    s_add_u32 m0, s48, 2048
    v_rcp_f32 v32, v32
    buffer_load_dwordx4 v26, s[36:39], 0 offen sc1 lds
    v_rcp_f32 v33, v33
    s_add_u32 m0, s48, 3072
    v_rcp_f32 v34, v34
    buffer_load_dwordx4 v27, s[36:39], 0 offen sc1 lds
    v_rcp_f32 v35, v35
    v_pk_fma_f32 v[140:141], v[76:77], v[28:29], v[140:141]
    v_pk_fma_f32 v[142:143], v[78:79], v[30:31], v[142:143]
    v_pk_fma_f32 v[144:145], v[80:81], v[32:33], v[144:145]
    v_pk_fma_f32 v[146:147], v[82:83], v[34:35], v[146:147]
    s_setprio 0
    s_waitcnt vmcnt(4) lgkmcnt(0)
    v_mfma_f32_32x32x16_bf16 v[68:83], v[172:175], v[56:59], v[100:115]
    v_exp_f32 v28, v84
    v_exp_f32 v29, v85
    v_exp_f32 v30, v86
    v_exp_f32 v31, v87
    v_exp_f32 v32, v88
    ds_read_b128 v[24:27], v1 offset:11264
    v_exp_f32 v33, v89
    v_exp_f32 v34, v90
    v_exp_f32 v35, v91
    v_pk_add_f32 v[28:29], v[28:29], v[4:5] op_sel_hi:[1,0]
    v_pk_add_f32 v[30:31], v[30:31], v[4:5] op_sel_hi:[1,0]
    v_pk_add_f32 v[32:33], v[32:33], v[4:5] op_sel_hi:[1,0]
    v_pk_add_f32 v[34:35], v[34:35], v[4:5] op_sel_hi:[1,0]
    v_smfmac_f32_32x32x32_bf16 v[68:83], v[164:167], v[36:43], v168
    v_rcp_f32 v28, v28
    v_rcp_f32 v29, v29
    v_rcp_f32 v30, v30
    v_rcp_f32 v31, v31
    v_cmp_le_u32 vcc, s15, v8
    v_rcp_f32 v32, v32
    s_mov_b64 exec, vcc
    buffer_load_dwordx4 v[52:55], v[8:9], s[20:23], 0 idxen offen
    s_mov_b64 exec, -1
    v_rcp_f32 v33, v33
    v_rcp_f32 v34, v34
    v_rcp_f32 v35, v35
    v_pk_fma_f32 v[148:149], v[84:85], v[28:29], v[148:149]
    v_pk_fma_f32 v[150:151], v[86:87], v[30:31], v[150:151]
    v_pk_fma_f32 v[152:153], v[88:89], v[32:33], v[152:153]
    v_pk_fma_f32 v[154:155], v[90:91], v[34:35], v[154:155]
    v_exp_f32 v28, v92
    v_exp_f32 v29, v93
    v_exp_f32 v30, v94
    v_exp_f32 v31, v95
    v_exp_f32 v32, v96
    s_waitcnt lgkmcnt(0)
    v_and_or_b32 v24, v24, s13, v20
    v_exp_f32 v33, v97
    v_and_or_b32 v25, v25, s13, v21
    v_exp_f32 v34, v98
    v_and_or_b32 v26, v26, s13, v22
    v_exp_f32 v35, v99
    v_and_or_b32 v27, v27, s13, v23
    v_pk_add_f32 v[28:29], v[28:29], v[4:5] op_sel_hi:[1,0]
    v_pk_add_f32 v[30:31], v[30:31], v[4:5] op_sel_hi:[1,0]
    v_pk_add_f32 v[32:33], v[32:33], v[4:5] op_sel_hi:[1,0]
    v_pk_add_f32 v[34:35], v[34:35], v[4:5] op_sel_hi:[1,0]
    v_rcp_f32 v28, v28
    v_rcp_f32 v29, v29
    v_rcp_f32 v30, v30
    v_rcp_f32 v31, v31
    v_rcp_f32 v32, v32
    v_rcp_f32 v33, v33
    v_rcp_f32 v34, v34
    v_rcp_f32 v35, v35
    s_cmp_eq_u32 s47, 7
    v_pk_fma_f32 v[156:157], v[92:93], v[28:29], v[156:157]
    v_pk_fma_f32 v[158:159], v[94:95], v[30:31], v[158:159]
    v_pk_fma_f32 v[160:161], v[96:97], v[32:33], v[160:161]
    v_pk_fma_f32 v[162:163], v[98:99], v[34:35], v[162:163]
    s_cbranch_scc1 M_FLUSH
    s_setprio 1
    v_mfma_f32_32x32x16_bf16 v[84:99], v[176:179], v[56:59], v[116:131]
    v_exp_f32 v28, v68
    v_and_or_b32 v4, v10, s14, 1.0
    v_exp_f32 v29, v69
    ds_read_b32 v10, v2 offset:28672
    v_exp_f32 v30, v70
    v_exp_f32 v31, v71
    v_exp_f32 v32, v72
    v_exp_f32 v33, v73
    v_exp_f32 v34, v74
    v_exp_f32 v35, v75
    v_pk_add_f32 v[28:29], v[28:29], v[4:5] op_sel_hi:[1,0]
    v_pk_add_f32 v[30:31], v[30:31], v[4:5] op_sel_hi:[1,0]
    v_pk_add_f32 v[32:33], v[32:33], v[4:5] op_sel_hi:[1,0]
    v_pk_add_f32 v[34:35], v[34:35], v[4:5] op_sel_hi:[1,0]
    v_smfmac_f32_32x32x32_bf16 v[84:99], v[164:167], v[44:51], v168
    v_rcp_f32 v28, v28
    v_rcp_f32 v29, v29
    v_rcp_f32 v30, v30
    s_waitcnt lgkmcnt(0)
    v_xor_b32 v236, v10, v9
    v_rcp_f32 v31, v31
    ds_read_b128 v[56:59], v236
    v_rcp_f32 v32, v32
    v_rcp_f32 v33, v33
    v_rcp_f32 v34, v34
    v_rcp_f32 v35, v35
    v_pk_fma_f32 v[132:133], v[68:69], v[28:29], v[132:133]
    v_pk_fma_f32 v[134:135], v[70:71], v[30:31], v[134:135]
    v_pk_fma_f32 v[136:137], v[72:73], v[32:33], v[136:137]
    v_pk_fma_f32 v[138:139], v[74:75], v[34:35], v[138:139]
    v_exp_f32 v28, v76
    s_waitcnt vmcnt(1)
    v_exp_f32 v29, v77
    ds_read_b128 v[36:39], v16
    v_exp_f32 v30, v78
    ds_read_b128 v[40:43], v17
    v_exp_f32 v31, v79
    ds_read_b128 v[44:47], v18
    v_exp_f32 v32, v80
    ds_read_b128 v[48:51], v19
    v_exp_f32 v33, v81
    v_exp_f32 v34, v82
    v_exp_f32 v35, v83
    s_add_u32 m0, s48, 0
    v_pk_add_f32 v[28:29], v[28:29], v[4:5] op_sel_hi:[1,0]
    v_pk_add_f32 v[30:31], v[30:31], v[4:5] op_sel_hi:[1,0]
    v_pk_add_f32 v[32:33], v[32:33], v[4:5] op_sel_hi:[1,0]
    v_pk_add_f32 v[34:35], v[34:35], v[4:5] op_sel_hi:[1,0]
    v_rcp_f32 v28, v28
    s_waitcnt lgkmcnt(0)
    buffer_load_dwordx4 v24, s[36:39], 0 offen sc1 lds
    v_rcp_f32 v29, v29
    s_add_u32 m0, s48, 1024
    v_rcp_f32 v30, v30
    buffer_load_dwordx4 v25, s[36:39], 0 offen sc1 lds
    v_rcp_f32 v31, v31
    s_add_u32 m0, s48, 2048
    v_rcp_f32 v32, v32
    buffer_load_dwordx4 v26, s[36:39], 0 offen sc1 lds
    v_rcp_f32 v33, v33
    s_add_u32 m0, s48, 3072
    v_rcp_f32 v34, v34
    buffer_load_dwordx4 v27, s[36:39], 0 offen sc1 lds
    v_rcp_f32 v35, v35
    v_pk_fma_f32 v[140:141], v[76:77], v[28:29], v[140:141]
    v_pk_fma_f32 v[142:143], v[78:79], v[30:31], v[142:143]
    v_pk_fma_f32 v[144:145], v[80:81], v[32:33], v[144:145]
    v_pk_fma_f32 v[146:147], v[82:83], v[34:35], v[146:147]
    s_setprio 0
    s_waitcnt vmcnt(4) lgkmcnt(0)
    v_mfma_f32_32x32x16_bf16 v[68:83], v[172:175], v[52:55], v[100:115]
    v_exp_f32 v28, v84
    v_exp_f32 v29, v85
    v_exp_f32 v30, v86
    v_exp_f32 v31, v87
    v_exp_f32 v32, v88
    ds_read_b128 v[24:27], v1 offset:12288
    v_exp_f32 v33, v89
    v_exp_f32 v34, v90
    v_exp_f32 v35, v91
    v_pk_add_f32 v[28:29], v[28:29], v[4:5] op_sel_hi:[1,0]
    v_pk_add_f32 v[30:31], v[30:31], v[4:5] op_sel_hi:[1,0]
    v_pk_add_f32 v[32:33], v[32:33], v[4:5] op_sel_hi:[1,0]
    v_pk_add_f32 v[34:35], v[34:35], v[4:5] op_sel_hi:[1,0]
    v_smfmac_f32_32x32x32_bf16 v[68:83], v[164:167], v[36:43], v168
    v_rcp_f32 v28, v28
    v_rcp_f32 v29, v29
    v_rcp_f32 v30, v30
    v_rcp_f32 v31, v31
    v_cmp_le_u32 vcc, s15, v10
    v_rcp_f32 v32, v32
    s_mov_b64 exec, vcc
    buffer_load_dwordx4 v[56:59], v[10:11], s[20:23], 0 idxen offen
    s_mov_b64 exec, -1
    v_rcp_f32 v33, v33
    v_rcp_f32 v34, v34
    v_rcp_f32 v35, v35
    v_pk_fma_f32 v[148:149], v[84:85], v[28:29], v[148:149]
    v_pk_fma_f32 v[150:151], v[86:87], v[30:31], v[150:151]
    v_pk_fma_f32 v[152:153], v[88:89], v[32:33], v[152:153]
    v_pk_fma_f32 v[154:155], v[90:91], v[34:35], v[154:155]
    v_exp_f32 v28, v92
    v_exp_f32 v29, v93
    v_exp_f32 v30, v94
    v_exp_f32 v31, v95
    v_exp_f32 v32, v96
    s_waitcnt lgkmcnt(0)
    v_and_or_b32 v24, v24, s13, v20
    v_exp_f32 v33, v97
    v_and_or_b32 v25, v25, s13, v21
    v_exp_f32 v34, v98
    v_and_or_b32 v26, v26, s13, v22
    v_exp_f32 v35, v99
    v_and_or_b32 v27, v27, s13, v23
    v_pk_add_f32 v[28:29], v[28:29], v[4:5] op_sel_hi:[1,0]
    v_pk_add_f32 v[30:31], v[30:31], v[4:5] op_sel_hi:[1,0]
    v_pk_add_f32 v[32:33], v[32:33], v[4:5] op_sel_hi:[1,0]
    v_pk_add_f32 v[34:35], v[34:35], v[4:5] op_sel_hi:[1,0]
    v_rcp_f32 v28, v28
    v_rcp_f32 v29, v29
    v_rcp_f32 v30, v30
    v_rcp_f32 v31, v31
    v_rcp_f32 v32, v32
    v_rcp_f32 v33, v33
    v_rcp_f32 v34, v34
    v_rcp_f32 v35, v35
    s_cmp_eq_u32 s47, 8
    v_pk_fma_f32 v[156:157], v[92:93], v[28:29], v[156:157]
    v_pk_fma_f32 v[158:159], v[94:95], v[30:31], v[158:159]
    v_pk_fma_f32 v[160:161], v[96:97], v[32:33], v[160:161]
    v_pk_fma_f32 v[162:163], v[98:99], v[34:35], v[162:163]
    s_cbranch_scc1 M_FLUSH
    s_setprio 1
    v_mfma_f32_32x32x16_bf16 v[84:99], v[176:179], v[52:55], v[116:131]
    v_exp_f32 v28, v68
    v_and_or_b32 v4, v8, s14, 1.0
    v_exp_f32 v29, v69
    ds_read_b32 v8, v2 offset:29696
    v_exp_f32 v30, v70
    v_exp_f32 v31, v71
    v_exp_f32 v32, v72
    v_exp_f32 v33, v73
    v_exp_f32 v34, v74
    v_exp_f32 v35, v75
    v_pk_add_f32 v[28:29], v[28:29], v[4:5] op_sel_hi:[1,0]
    v_pk_add_f32 v[30:31], v[30:31], v[4:5] op_sel_hi:[1,0]
    v_pk_add_f32 v[32:33], v[32:33], v[4:5] op_sel_hi:[1,0]
    v_pk_add_f32 v[34:35], v[34:35], v[4:5] op_sel_hi:[1,0]
    v_smfmac_f32_32x32x32_bf16 v[84:99], v[164:167], v[44:51], v168
    v_rcp_f32 v28, v28
    v_rcp_f32 v29, v29
    v_rcp_f32 v30, v30
    s_waitcnt lgkmcnt(0)
    v_xor_b32 v236, v8, v9
    v_rcp_f32 v31, v31
    ds_read_b128 v[52:55], v236
    v_rcp_f32 v32, v32
    v_rcp_f32 v33, v33
    v_rcp_f32 v34, v34
    v_rcp_f32 v35, v35
    v_pk_fma_f32 v[132:133], v[68:69], v[28:29], v[132:133]
    v_pk_fma_f32 v[134:135], v[70:71], v[30:31], v[134:135]
    v_pk_fma_f32 v[136:137], v[72:73], v[32:33], v[136:137]
    v_pk_fma_f32 v[138:139], v[74:75], v[34:35], v[138:139]
    v_exp_f32 v28, v76
    s_waitcnt vmcnt(1)
    v_exp_f32 v29, v77
    ds_read_b128 v[36:39], v16
    v_exp_f32 v30, v78
    ds_read_b128 v[40:43], v17
    v_exp_f32 v31, v79
    ds_read_b128 v[44:47], v18
    v_exp_f32 v32, v80
    ds_read_b128 v[48:51], v19
    v_exp_f32 v33, v81
    v_exp_f32 v34, v82
    v_exp_f32 v35, v83
    s_add_u32 m0, s48, 0
    v_pk_add_f32 v[28:29], v[28:29], v[4:5] op_sel_hi:[1,0]
    v_pk_add_f32 v[30:31], v[30:31], v[4:5] op_sel_hi:[1,0]
    v_pk_add_f32 v[32:33], v[32:33], v[4:5] op_sel_hi:[1,0]
    v_pk_add_f32 v[34:35], v[34:35], v[4:5] op_sel_hi:[1,0]
    v_rcp_f32 v28, v28
    s_waitcnt lgkmcnt(0)
    buffer_load_dwordx4 v24, s[36:39], 0 offen sc1 lds
    v_rcp_f32 v29, v29
    s_add_u32 m0, s48, 1024
    v_rcp_f32 v30, v30
    buffer_load_dwordx4 v25, s[36:39], 0 offen sc1 lds
    v_rcp_f32 v31, v31
    s_add_u32 m0, s48, 2048
    v_rcp_f32 v32, v32
    buffer_load_dwordx4 v26, s[36:39], 0 offen sc1 lds
    v_rcp_f32 v33, v33
    s_add_u32 m0, s48, 3072
    v_rcp_f32 v34, v34
    buffer_load_dwordx4 v27, s[36:39], 0 offen sc1 lds
    v_rcp_f32 v35, v35
    v_pk_fma_f32 v[140:141], v[76:77], v[28:29], v[140:141]
    v_pk_fma_f32 v[142:143], v[78:79], v[30:31], v[142:143]
    v_pk_fma_f32 v[144:145], v[80:81], v[32:33], v[144:145]
    v_pk_fma_f32 v[146:147], v[82:83], v[34:35], v[146:147]
    s_setprio 0
    s_waitcnt vmcnt(4) lgkmcnt(0)
    v_mfma_f32_32x32x16_bf16 v[68:83], v[172:175], v[56:59], v[100:115]
    v_exp_f32 v28, v84
    v_exp_f32 v29, v85
    v_exp_f32 v30, v86
    v_exp_f32 v31, v87
    v_exp_f32 v32, v88
    ds_read_b128 v[24:27], v1 offset:13312
    v_exp_f32 v33, v89
    v_exp_f32 v34, v90
    v_exp_f32 v35, v91
    v_pk_add_f32 v[28:29], v[28:29], v[4:5] op_sel_hi:[1,0]
    v_pk_add_f32 v[30:31], v[30:31], v[4:5] op_sel_hi:[1,0]
    v_pk_add_f32 v[32:33], v[32:33], v[4:5] op_sel_hi:[1,0]
    v_pk_add_f32 v[34:35], v[34:35], v[4:5] op_sel_hi:[1,0]
    v_smfmac_f32_32x32x32_bf16 v[68:83], v[164:167], v[36:43], v168
    v_rcp_f32 v28, v28
    v_rcp_f32 v29, v29
    v_rcp_f32 v30, v30
    v_rcp_f32 v31, v31
    v_cmp_le_u32 vcc, s15, v8
    v_rcp_f32 v32, v32
    s_mov_b64 exec, vcc
    buffer_load_dwordx4 v[52:55], v[8:9], s[20:23], 0 idxen offen
    s_mov_b64 exec, -1
    v_rcp_f32 v33, v33
    v_rcp_f32 v34, v34
    v_rcp_f32 v35, v35
    v_pk_fma_f32 v[148:149], v[84:85], v[28:29], v[148:149]
    v_pk_fma_f32 v[150:151], v[86:87], v[30:31], v[150:151]
    v_pk_fma_f32 v[152:153], v[88:89], v[32:33], v[152:153]
    v_pk_fma_f32 v[154:155], v[90:91], v[34:35], v[154:155]
    v_exp_f32 v28, v92
    v_exp_f32 v29, v93
    v_exp_f32 v30, v94
    v_exp_f32 v31, v95
    v_exp_f32 v32, v96
    s_waitcnt lgkmcnt(0)
    v_and_or_b32 v24, v24, s13, v20
    v_exp_f32 v33, v97
    v_and_or_b32 v25, v25, s13, v21
    v_exp_f32 v34, v98
    v_and_or_b32 v26, v26, s13, v22
    v_exp_f32 v35, v99
    v_and_or_b32 v27, v27, s13, v23
    v_pk_add_f32 v[28:29], v[28:29], v[4:5] op_sel_hi:[1,0]
    v_pk_add_f32 v[30:31], v[30:31], v[4:5] op_sel_hi:[1,0]
    v_pk_add_f32 v[32:33], v[32:33], v[4:5] op_sel_hi:[1,0]
    v_pk_add_f32 v[34:35], v[34:35], v[4:5] op_sel_hi:[1,0]
    v_rcp_f32 v28, v28
    v_rcp_f32 v29, v29
    v_rcp_f32 v30, v30
    v_rcp_f32 v31, v31
    v_rcp_f32 v32, v32
    v_rcp_f32 v33, v33
    v_rcp_f32 v34, v34
    v_rcp_f32 v35, v35
    s_cmp_eq_u32 s47, 9
    v_pk_fma_f32 v[156:157], v[92:93], v[28:29], v[156:157]
    v_pk_fma_f32 v[158:159], v[94:95], v[30:31], v[158:159]
    v_pk_fma_f32 v[160:161], v[96:97], v[32:33], v[160:161]
    v_pk_fma_f32 v[162:163], v[98:99], v[34:35], v[162:163]
    s_cbranch_scc1 M_FLUSH
    s_setprio 1
    v_mfma_f32_32x32x16_bf16 v[84:99], v[176:179], v[56:59], v[116:131]
    v_exp_f32 v28, v68
    v_and_or_b32 v4, v10, s14, 1.0
    v_exp_f32 v29, v69
    ds_read_b32 v10, v2 offset:30720
    v_exp_f32 v30, v70
    v_exp_f32 v31, v71
    v_exp_f32 v32, v72
    v_exp_f32 v33, v73
    v_exp_f32 v34, v74
    v_exp_f32 v35, v75
    v_pk_add_f32 v[28:29], v[28:29], v[4:5] op_sel_hi:[1,0]
    v_pk_add_f32 v[30:31], v[30:31], v[4:5] op_sel_hi:[1,0]
    v_pk_add_f32 v[32:33], v[32:33], v[4:5] op_sel_hi:[1,0]
    v_pk_add_f32 v[34:35], v[34:35], v[4:5] op_sel_hi:[1,0]
    v_smfmac_f32_32x32x32_bf16 v[84:99], v[164:167], v[44:51], v168
    v_rcp_f32 v28, v28
    v_rcp_f32 v29, v29
    v_rcp_f32 v30, v30
    s_waitcnt lgkmcnt(0)
    v_xor_b32 v236, v10, v9
    v_rcp_f32 v31, v31
    ds_read_b128 v[56:59], v236
    v_rcp_f32 v32, v32
    v_rcp_f32 v33, v33
    v_rcp_f32 v34, v34
    v_rcp_f32 v35, v35
    v_pk_fma_f32 v[132:133], v[68:69], v[28:29], v[132:133]
    v_pk_fma_f32 v[134:135], v[70:71], v[30:31], v[134:135]
    v_pk_fma_f32 v[136:137], v[72:73], v[32:33], v[136:137]
    v_pk_fma_f32 v[138:139], v[74:75], v[34:35], v[138:139]
    v_exp_f32 v28, v76
    s_waitcnt vmcnt(1)
    v_exp_f32 v29, v77
    ds_read_b128 v[36:39], v16
    v_exp_f32 v30, v78
    ds_read_b128 v[40:43], v17
    v_exp_f32 v31, v79
    ds_read_b128 v[44:47], v18
    v_exp_f32 v32, v80
    ds_read_b128 v[48:51], v19
    v_exp_f32 v33, v81
    v_exp_f32 v34, v82
    v_exp_f32 v35, v83
    s_add_u32 m0, s48, 0
    v_pk_add_f32 v[28:29], v[28:29], v[4:5] op_sel_hi:[1,0]
    v_pk_add_f32 v[30:31], v[30:31], v[4:5] op_sel_hi:[1,0]
    v_pk_add_f32 v[32:33], v[32:33], v[4:5] op_sel_hi:[1,0]
    v_pk_add_f32 v[34:35], v[34:35], v[4:5] op_sel_hi:[1,0]
    v_rcp_f32 v28, v28
    s_waitcnt lgkmcnt(0)
    buffer_load_dwordx4 v24, s[36:39], 0 offen sc1 lds
    v_rcp_f32 v29, v29
    s_add_u32 m0, s48, 1024
    v_rcp_f32 v30, v30
    buffer_load_dwordx4 v25, s[36:39], 0 offen sc1 lds
    v_rcp_f32 v31, v31
    s_add_u32 m0, s48, 2048
    v_rcp_f32 v32, v32
    buffer_load_dwordx4 v26, s[36:39], 0 offen sc1 lds
    v_rcp_f32 v33, v33
    s_add_u32 m0, s48, 3072
    v_rcp_f32 v34, v34
    buffer_load_dwordx4 v27, s[36:39], 0 offen sc1 lds
    v_rcp_f32 v35, v35
    v_pk_fma_f32 v[140:141], v[76:77], v[28:29], v[140:141]
    v_pk_fma_f32 v[142:143], v[78:79], v[30:31], v[142:143]
    v_pk_fma_f32 v[144:145], v[80:81], v[32:33], v[144:145]
    v_pk_fma_f32 v[146:147], v[82:83], v[34:35], v[146:147]
    s_setprio 0
    s_waitcnt vmcnt(4) lgkmcnt(0)
    v_mfma_f32_32x32x16_bf16 v[68:83], v[172:175], v[52:55], v[100:115]
    v_exp_f32 v28, v84
    v_exp_f32 v29, v85
    v_exp_f32 v30, v86
    v_exp_f32 v31, v87
    v_exp_f32 v32, v88
    ds_read_b128 v[24:27], v1 offset:14336
    v_exp_f32 v33, v89
    v_exp_f32 v34, v90
    v_exp_f32 v35, v91
    v_pk_add_f32 v[28:29], v[28:29], v[4:5] op_sel_hi:[1,0]
    v_pk_add_f32 v[30:31], v[30:31], v[4:5] op_sel_hi:[1,0]
    v_pk_add_f32 v[32:33], v[32:33], v[4:5] op_sel_hi:[1,0]
    v_pk_add_f32 v[34:35], v[34:35], v[4:5] op_sel_hi:[1,0]
    v_smfmac_f32_32x32x32_bf16 v[68:83], v[164:167], v[36:43], v168
    v_rcp_f32 v28, v28
    v_rcp_f32 v29, v29
    v_rcp_f32 v30, v30
    v_rcp_f32 v31, v31
    v_cmp_le_u32 vcc, s15, v10
    v_rcp_f32 v32, v32
    s_mov_b64 exec, vcc
    buffer_load_dwordx4 v[56:59], v[10:11], s[20:23], 0 idxen offen
    s_mov_b64 exec, -1
    v_rcp_f32 v33, v33
    v_rcp_f32 v34, v34
    v_rcp_f32 v35, v35
    v_pk_fma_f32 v[148:149], v[84:85], v[28:29], v[148:149]
    v_pk_fma_f32 v[150:151], v[86:87], v[30:31], v[150:151]
    v_pk_fma_f32 v[152:153], v[88:89], v[32:33], v[152:153]
    v_pk_fma_f32 v[154:155], v[90:91], v[34:35], v[154:155]
    v_exp_f32 v28, v92
    v_exp_f32 v29, v93
    v_exp_f32 v30, v94
    v_exp_f32 v31, v95
    v_exp_f32 v32, v96
    s_waitcnt lgkmcnt(0)
    v_and_or_b32 v24, v24, s13, v20
    v_exp_f32 v33, v97
    v_and_or_b32 v25, v25, s13, v21
    v_exp_f32 v34, v98
    v_and_or_b32 v26, v26, s13, v22
    v_exp_f32 v35, v99
    v_and_or_b32 v27, v27, s13, v23
    v_pk_add_f32 v[28:29], v[28:29], v[4:5] op_sel_hi:[1,0]
    v_pk_add_f32 v[30:31], v[30:31], v[4:5] op_sel_hi:[1,0]
    v_pk_add_f32 v[32:33], v[32:33], v[4:5] op_sel_hi:[1,0]
    v_pk_add_f32 v[34:35], v[34:35], v[4:5] op_sel_hi:[1,0]
    v_rcp_f32 v28, v28
    v_rcp_f32 v29, v29
    v_rcp_f32 v30, v30
    v_rcp_f32 v31, v31
    v_rcp_f32 v32, v32
    v_rcp_f32 v33, v33
    v_rcp_f32 v34, v34
    v_rcp_f32 v35, v35
    s_cmp_eq_u32 s47, 10
    v_pk_fma_f32 v[156:157], v[92:93], v[28:29], v[156:157]
    v_pk_fma_f32 v[158:159], v[94:95], v[30:31], v[158:159]
    v_pk_fma_f32 v[160:161], v[96:97], v[32:33], v[160:161]
    v_pk_fma_f32 v[162:163], v[98:99], v[34:35], v[162:163]
    s_cbranch_scc1 M_FLUSH
    s_setprio 1
    v_mfma_f32_32x32x16_bf16 v[84:99], v[176:179], v[52:55], v[116:131]
    v_exp_f32 v28, v68
    v_and_or_b32 v4, v8, s14, 1.0
    v_exp_f32 v29, v69
    ds_read_b32 v8, v2 offset:31744
    v_exp_f32 v30, v70
    v_exp_f32 v31, v71
    v_exp_f32 v32, v72
    v_exp_f32 v33, v73
    v_exp_f32 v34, v74
    v_exp_f32 v35, v75
    v_pk_add_f32 v[28:29], v[28:29], v[4:5] op_sel_hi:[1,0]
    v_pk_add_f32 v[30:31], v[30:31], v[4:5] op_sel_hi:[1,0]
    v_pk_add_f32 v[32:33], v[32:33], v[4:5] op_sel_hi:[1,0]
    v_pk_add_f32 v[34:35], v[34:35], v[4:5] op_sel_hi:[1,0]
    v_smfmac_f32_32x32x32_bf16 v[84:99], v[164:167], v[44:51], v168
    v_rcp_f32 v28, v28
    v_rcp_f32 v29, v29
    v_rcp_f32 v30, v30
    s_waitcnt lgkmcnt(0)
    v_xor_b32 v236, v8, v9
    v_rcp_f32 v31, v31
    ds_read_b128 v[52:55], v236
    v_rcp_f32 v32, v32
    v_rcp_f32 v33, v33
    v_rcp_f32 v34, v34
    v_rcp_f32 v35, v35
    v_pk_fma_f32 v[132:133], v[68:69], v[28:29], v[132:133]
    v_pk_fma_f32 v[134:135], v[70:71], v[30:31], v[134:135]
    v_pk_fma_f32 v[136:137], v[72:73], v[32:33], v[136:137]
    v_pk_fma_f32 v[138:139], v[74:75], v[34:35], v[138:139]
    v_exp_f32 v28, v76
    s_waitcnt vmcnt(1)
    v_exp_f32 v29, v77
    ds_read_b128 v[36:39], v16
    v_exp_f32 v30, v78
    ds_read_b128 v[40:43], v17
    v_exp_f32 v31, v79
    ds_read_b128 v[44:47], v18
    v_exp_f32 v32, v80
    ds_read_b128 v[48:51], v19
    v_exp_f32 v33, v81
    v_exp_f32 v34, v82
    v_exp_f32 v35, v83
    s_add_u32 m0, s48, 0
    v_pk_add_f32 v[28:29], v[28:29], v[4:5] op_sel_hi:[1,0]
    v_pk_add_f32 v[30:31], v[30:31], v[4:5] op_sel_hi:[1,0]
    v_pk_add_f32 v[32:33], v[32:33], v[4:5] op_sel_hi:[1,0]
    v_pk_add_f32 v[34:35], v[34:35], v[4:5] op_sel_hi:[1,0]
    v_rcp_f32 v28, v28
    s_waitcnt lgkmcnt(0)
    buffer_load_dwordx4 v24, s[36:39], 0 offen sc1 lds
    v_rcp_f32 v29, v29
    s_add_u32 m0, s48, 1024
    v_rcp_f32 v30, v30
    buffer_load_dwordx4 v25, s[36:39], 0 offen sc1 lds
    v_rcp_f32 v31, v31
    s_add_u32 m0, s48, 2048
    v_rcp_f32 v32, v32
    buffer_load_dwordx4 v26, s[36:39], 0 offen sc1 lds
    v_rcp_f32 v33, v33
    s_add_u32 m0, s48, 3072
    v_rcp_f32 v34, v34
    buffer_load_dwordx4 v27, s[36:39], 0 offen sc1 lds
    v_rcp_f32 v35, v35
    v_pk_fma_f32 v[140:141], v[76:77], v[28:29], v[140:141]
    v_pk_fma_f32 v[142:143], v[78:79], v[30:31], v[142:143]
    v_pk_fma_f32 v[144:145], v[80:81], v[32:33], v[144:145]
    v_pk_fma_f32 v[146:147], v[82:83], v[34:35], v[146:147]
    s_setprio 0
    s_waitcnt vmcnt(4) lgkmcnt(0)
    v_mfma_f32_32x32x16_bf16 v[68:83], v[172:175], v[56:59], v[100:115]
    v_exp_f32 v28, v84
    v_exp_f32 v29, v85
    v_exp_f32 v30, v86
    v_exp_f32 v31, v87
    v_exp_f32 v32, v88
    ds_read_b128 v[24:27], v1 offset:15360
    v_exp_f32 v33, v89
    v_exp_f32 v34, v90
    v_exp_f32 v35, v91
    v_pk_add_f32 v[28:29], v[28:29], v[4:5] op_sel_hi:[1,0]
    v_pk_add_f32 v[30:31], v[30:31], v[4:5] op_sel_hi:[1,0]
    v_pk_add_f32 v[32:33], v[32:33], v[4:5] op_sel_hi:[1,0]
    v_pk_add_f32 v[34:35], v[34:35], v[4:5] op_sel_hi:[1,0]
    v_smfmac_f32_32x32x32_bf16 v[68:83], v[164:167], v[36:43], v168
    v_rcp_f32 v28, v28
    v_rcp_f32 v29, v29
    v_rcp_f32 v30, v30
    v_rcp_f32 v31, v31
    v_cmp_le_u32 vcc, s15, v8
    v_rcp_f32 v32, v32
    s_mov_b64 exec, vcc
    buffer_load_dwordx4 v[52:55], v[8:9], s[20:23], 0 idxen offen
    s_mov_b64 exec, -1
    v_rcp_f32 v33, v33
    v_rcp_f32 v34, v34
    v_rcp_f32 v35, v35
    v_pk_fma_f32 v[148:149], v[84:85], v[28:29], v[148:149]
    v_pk_fma_f32 v[150:151], v[86:87], v[30:31], v[150:151]
    v_pk_fma_f32 v[152:153], v[88:89], v[32:33], v[152:153]
    v_pk_fma_f32 v[154:155], v[90:91], v[34:35], v[154:155]
    v_exp_f32 v28, v92
    v_exp_f32 v29, v93
    v_exp_f32 v30, v94
    v_exp_f32 v31, v95
    v_exp_f32 v32, v96
    s_waitcnt lgkmcnt(0)
    v_and_or_b32 v24, v24, s13, v20
    v_exp_f32 v33, v97
    v_and_or_b32 v25, v25, s13, v21
    v_exp_f32 v34, v98
    v_and_or_b32 v26, v26, s13, v22
    v_exp_f32 v35, v99
    v_and_or_b32 v27, v27, s13, v23
    v_pk_add_f32 v[28:29], v[28:29], v[4:5] op_sel_hi:[1,0]
    v_pk_add_f32 v[30:31], v[30:31], v[4:5] op_sel_hi:[1,0]
    v_pk_add_f32 v[32:33], v[32:33], v[4:5] op_sel_hi:[1,0]
    v_pk_add_f32 v[34:35], v[34:35], v[4:5] op_sel_hi:[1,0]
    v_rcp_f32 v28, v28
    v_rcp_f32 v29, v29
    v_rcp_f32 v30, v30
    v_rcp_f32 v31, v31
    v_rcp_f32 v32, v32
    v_rcp_f32 v33, v33
    v_rcp_f32 v34, v34
    v_rcp_f32 v35, v35
    s_cmp_eq_u32 s47, 11
    v_pk_fma_f32 v[156:157], v[92:93], v[28:29], v[156:157]
    v_pk_fma_f32 v[158:159], v[94:95], v[30:31], v[158:159]
    v_pk_fma_f32 v[160:161], v[96:97], v[32:33], v[160:161]
    v_pk_fma_f32 v[162:163], v[98:99], v[34:35], v[162:163]
    s_cbranch_scc1 M_FLUSH
    s_setprio 1
    v_mfma_f32_32x32x16_bf16 v[84:99], v[176:179], v[56:59], v[116:131]
    v_exp_f32 v28, v68
    v_and_or_b32 v4, v10, s14, 1.0
    v_exp_f32 v29, v69
    ds_read_b32 v10, v2 offset:32768
    v_exp_f32 v30, v70
    v_exp_f32 v31, v71
    v_exp_f32 v32, v72
    v_exp_f32 v33, v73
    v_exp_f32 v34, v74
    v_exp_f32 v35, v75
    v_pk_add_f32 v[28:29], v[28:29], v[4:5] op_sel_hi:[1,0]
    v_pk_add_f32 v[30:31], v[30:31], v[4:5] op_sel_hi:[1,0]
    v_pk_add_f32 v[32:33], v[32:33], v[4:5] op_sel_hi:[1,0]
    v_pk_add_f32 v[34:35], v[34:35], v[4:5] op_sel_hi:[1,0]
    v_smfmac_f32_32x32x32_bf16 v[84:99], v[164:167], v[44:51], v168
    v_rcp_f32 v28, v28
    v_rcp_f32 v29, v29
    v_rcp_f32 v30, v30
    s_waitcnt lgkmcnt(0)
    v_xor_b32 v236, v10, v9
    v_rcp_f32 v31, v31
    ds_read_b128 v[56:59], v236
    v_rcp_f32 v32, v32
    v_rcp_f32 v33, v33
    v_rcp_f32 v34, v34
    v_rcp_f32 v35, v35
    v_pk_fma_f32 v[132:133], v[68:69], v[28:29], v[132:133]
    v_pk_fma_f32 v[134:135], v[70:71], v[30:31], v[134:135]
    v_pk_fma_f32 v[136:137], v[72:73], v[32:33], v[136:137]
    v_pk_fma_f32 v[138:139], v[74:75], v[34:35], v[138:139]
    v_exp_f32 v28, v76
    s_waitcnt vmcnt(1)
    v_exp_f32 v29, v77
    ds_read_b128 v[36:39], v16
    v_exp_f32 v30, v78
    ds_read_b128 v[40:43], v17
    v_exp_f32 v31, v79
    ds_read_b128 v[44:47], v18
    v_exp_f32 v32, v80
    ds_read_b128 v[48:51], v19
    v_exp_f32 v33, v81
    v_exp_f32 v34, v82
    v_exp_f32 v35, v83
    s_add_u32 m0, s48, 0
    v_pk_add_f32 v[28:29], v[28:29], v[4:5] op_sel_hi:[1,0]
    v_pk_add_f32 v[30:31], v[30:31], v[4:5] op_sel_hi:[1,0]
    v_pk_add_f32 v[32:33], v[32:33], v[4:5] op_sel_hi:[1,0]
    v_pk_add_f32 v[34:35], v[34:35], v[4:5] op_sel_hi:[1,0]
    v_rcp_f32 v28, v28
    s_waitcnt lgkmcnt(0)
    buffer_load_dwordx4 v24, s[36:39], 0 offen sc1 lds
    v_rcp_f32 v29, v29
    s_add_u32 m0, s48, 1024
    v_rcp_f32 v30, v30
    buffer_load_dwordx4 v25, s[36:39], 0 offen sc1 lds
    v_rcp_f32 v31, v31
    s_add_u32 m0, s48, 2048
    v_rcp_f32 v32, v32
    buffer_load_dwordx4 v26, s[36:39], 0 offen sc1 lds
    v_rcp_f32 v33, v33
    s_add_u32 m0, s48, 3072
    v_rcp_f32 v34, v34
    buffer_load_dwordx4 v27, s[36:39], 0 offen sc1 lds
    v_rcp_f32 v35, v35
    v_pk_fma_f32 v[140:141], v[76:77], v[28:29], v[140:141]
    v_pk_fma_f32 v[142:143], v[78:79], v[30:31], v[142:143]
    v_pk_fma_f32 v[144:145], v[80:81], v[32:33], v[144:145]
    v_pk_fma_f32 v[146:147], v[82:83], v[34:35], v[146:147]
    s_setprio 0
    s_waitcnt vmcnt(4) lgkmcnt(0)
    v_mfma_f32_32x32x16_bf16 v[68:83], v[172:175], v[52:55], v[100:115]
    v_exp_f32 v28, v84
    v_exp_f32 v29, v85
    v_exp_f32 v30, v86
    v_exp_f32 v31, v87
    v_exp_f32 v32, v88
    ds_read_b128 v[24:27], v1 offset:16384
    v_exp_f32 v33, v89
    v_exp_f32 v34, v90
    v_exp_f32 v35, v91
    v_pk_add_f32 v[28:29], v[28:29], v[4:5] op_sel_hi:[1,0]
    v_pk_add_f32 v[30:31], v[30:31], v[4:5] op_sel_hi:[1,0]
    v_pk_add_f32 v[32:33], v[32:33], v[4:5] op_sel_hi:[1,0]
    v_pk_add_f32 v[34:35], v[34:35], v[4:5] op_sel_hi:[1,0]
    v_smfmac_f32_32x32x32_bf16 v[68:83], v[164:167], v[36:43], v168
    v_rcp_f32 v28, v28
    v_rcp_f32 v29, v29
    v_rcp_f32 v30, v30
    v_rcp_f32 v31, v31
    v_cmp_le_u32 vcc, s15, v10
    v_rcp_f32 v32, v32
    s_mov_b64 exec, vcc
    buffer_load_dwordx4 v[56:59], v[10:11], s[20:23], 0 idxen offen
    s_mov_b64 exec, -1
    v_rcp_f32 v33, v33
    v_rcp_f32 v34, v34
    v_rcp_f32 v35, v35
    v_pk_fma_f32 v[148:149], v[84:85], v[28:29], v[148:149]
    v_pk_fma_f32 v[150:151], v[86:87], v[30:31], v[150:151]
    v_pk_fma_f32 v[152:153], v[88:89], v[32:33], v[152:153]
    v_pk_fma_f32 v[154:155], v[90:91], v[34:35], v[154:155]
    v_exp_f32 v28, v92
    v_exp_f32 v29, v93
    v_exp_f32 v30, v94
    v_exp_f32 v31, v95
    v_exp_f32 v32, v96
    s_waitcnt lgkmcnt(0)
    v_and_or_b32 v24, v24, s13, v20
    v_exp_f32 v33, v97
    v_and_or_b32 v25, v25, s13, v21
    v_exp_f32 v34, v98
    v_and_or_b32 v26, v26, s13, v22
    v_exp_f32 v35, v99
    v_and_or_b32 v27, v27, s13, v23
    v_pk_add_f32 v[28:29], v[28:29], v[4:5] op_sel_hi:[1,0]
    v_pk_add_f32 v[30:31], v[30:31], v[4:5] op_sel_hi:[1,0]
    v_pk_add_f32 v[32:33], v[32:33], v[4:5] op_sel_hi:[1,0]
    v_pk_add_f32 v[34:35], v[34:35], v[4:5] op_sel_hi:[1,0]
    v_rcp_f32 v28, v28
    v_rcp_f32 v29, v29
    v_rcp_f32 v30, v30
    v_rcp_f32 v31, v31
    v_rcp_f32 v32, v32
    v_rcp_f32 v33, v33
    v_rcp_f32 v34, v34
    v_rcp_f32 v35, v35
    s_cmp_eq_u32 s47, 12
    v_pk_fma_f32 v[156:157], v[92:93], v[28:29], v[156:157]
    v_pk_fma_f32 v[158:159], v[94:95], v[30:31], v[158:159]
    v_pk_fma_f32 v[160:161], v[96:97], v[32:33], v[160:161]
    v_pk_fma_f32 v[162:163], v[98:99], v[34:35], v[162:163]
    s_cbranch_scc1 M_FLUSH
    s_setprio 1
    v_mfma_f32_32x32x16_bf16 v[84:99], v[176:179], v[52:55], v[116:131]
    v_exp_f32 v28, v68
    v_and_or_b32 v4, v8, s14, 1.0
    v_exp_f32 v29, v69
    ds_read_b32 v8, v2 offset:33792
    v_exp_f32 v30, v70
    v_exp_f32 v31, v71
    v_exp_f32 v32, v72
    v_exp_f32 v33, v73
    v_exp_f32 v34, v74
    v_exp_f32 v35, v75
    v_pk_add_f32 v[28:29], v[28:29], v[4:5] op_sel_hi:[1,0]
    v_pk_add_f32 v[30:31], v[30:31], v[4:5] op_sel_hi:[1,0]
    v_pk_add_f32 v[32:33], v[32:33], v[4:5] op_sel_hi:[1,0]
    v_pk_add_f32 v[34:35], v[34:35], v[4:5] op_sel_hi:[1,0]
    v_smfmac_f32_32x32x32_bf16 v[84:99], v[164:167], v[44:51], v168
    v_rcp_f32 v28, v28
    v_rcp_f32 v29, v29
    v_rcp_f32 v30, v30
    s_waitcnt lgkmcnt(0)
    v_xor_b32 v236, v8, v9
    v_rcp_f32 v31, v31
    ds_read_b128 v[52:55], v236
    v_rcp_f32 v32, v32
    v_rcp_f32 v33, v33
    v_rcp_f32 v34, v34
    v_rcp_f32 v35, v35
    v_pk_fma_f32 v[132:133], v[68:69], v[28:29], v[132:133]
    v_pk_fma_f32 v[134:135], v[70:71], v[30:31], v[134:135]
    v_pk_fma_f32 v[136:137], v[72:73], v[32:33], v[136:137]
    v_pk_fma_f32 v[138:139], v[74:75], v[34:35], v[138:139]
    v_exp_f32 v28, v76
    s_waitcnt vmcnt(1)
    v_exp_f32 v29, v77
    ds_read_b128 v[36:39], v16
    v_exp_f32 v30, v78
    ds_read_b128 v[40:43], v17
    v_exp_f32 v31, v79
    ds_read_b128 v[44:47], v18
    v_exp_f32 v32, v80
    ds_read_b128 v[48:51], v19
    v_exp_f32 v33, v81
    v_exp_f32 v34, v82
    v_exp_f32 v35, v83
    s_add_u32 m0, s48, 0
    v_pk_add_f32 v[28:29], v[28:29], v[4:5] op_sel_hi:[1,0]
    v_pk_add_f32 v[30:31], v[30:31], v[4:5] op_sel_hi:[1,0]
    v_pk_add_f32 v[32:33], v[32:33], v[4:5] op_sel_hi:[1,0]
    v_pk_add_f32 v[34:35], v[34:35], v[4:5] op_sel_hi:[1,0]
    v_rcp_f32 v28, v28
    s_waitcnt lgkmcnt(0)
    buffer_load_dwordx4 v24, s[36:39], 0 offen sc1 lds
    v_rcp_f32 v29, v29
    s_add_u32 m0, s48, 1024
    v_rcp_f32 v30, v30
    buffer_load_dwordx4 v25, s[36:39], 0 offen sc1 lds
    v_rcp_f32 v31, v31
    s_add_u32 m0, s48, 2048
    v_rcp_f32 v32, v32
    buffer_load_dwordx4 v26, s[36:39], 0 offen sc1 lds
    v_rcp_f32 v33, v33
    s_add_u32 m0, s48, 3072
    v_rcp_f32 v34, v34
    buffer_load_dwordx4 v27, s[36:39], 0 offen sc1 lds
    v_rcp_f32 v35, v35
    v_pk_fma_f32 v[140:141], v[76:77], v[28:29], v[140:141]
    v_pk_fma_f32 v[142:143], v[78:79], v[30:31], v[142:143]
    v_pk_fma_f32 v[144:145], v[80:81], v[32:33], v[144:145]
    v_pk_fma_f32 v[146:147], v[82:83], v[34:35], v[146:147]
    s_setprio 0
    s_waitcnt vmcnt(4) lgkmcnt(0)
    v_mfma_f32_32x32x16_bf16 v[68:83], v[172:175], v[56:59], v[100:115]
    v_exp_f32 v28, v84
    v_exp_f32 v29, v85
    v_exp_f32 v30, v86
    v_exp_f32 v31, v87
    v_exp_f32 v32, v88
    ds_read_b128 v[24:27], v1 offset:17408
    v_exp_f32 v33, v89
    v_exp_f32 v34, v90
    v_exp_f32 v35, v91
    v_pk_add_f32 v[28:29], v[28:29], v[4:5] op_sel_hi:[1,0]
    v_pk_add_f32 v[30:31], v[30:31], v[4:5] op_sel_hi:[1,0]
    v_pk_add_f32 v[32:33], v[32:33], v[4:5] op_sel_hi:[1,0]
    v_pk_add_f32 v[34:35], v[34:35], v[4:5] op_sel_hi:[1,0]
    v_smfmac_f32_32x32x32_bf16 v[68:83], v[164:167], v[36:43], v168
    v_rcp_f32 v28, v28
    v_rcp_f32 v29, v29
    v_rcp_f32 v30, v30
    v_rcp_f32 v31, v31
    v_cmp_le_u32 vcc, s15, v8
    v_rcp_f32 v32, v32
    s_mov_b64 exec, vcc
    buffer_load_dwordx4 v[52:55], v[8:9], s[20:23], 0 idxen offen
    s_mov_b64 exec, -1
    v_rcp_f32 v33, v33
    v_rcp_f32 v34, v34
    v_rcp_f32 v35, v35
    v_pk_fma_f32 v[148:149], v[84:85], v[28:29], v[148:149]
    v_pk_fma_f32 v[150:151], v[86:87], v[30:31], v[150:151]
    v_pk_fma_f32 v[152:153], v[88:89], v[32:33], v[152:153]
    v_pk_fma_f32 v[154:155], v[90:91], v[34:35], v[154:155]
    v_exp_f32 v28, v92
    v_exp_f32 v29, v93
    v_exp_f32 v30, v94
    v_exp_f32 v31, v95
    v_exp_f32 v32, v96
    s_waitcnt lgkmcnt(0)
    v_and_or_b32 v24, v24, s13, v20
    v_exp_f32 v33, v97
    v_and_or_b32 v25, v25, s13, v21
    v_exp_f32 v34, v98
    v_and_or_b32 v26, v26, s13, v22
    v_exp_f32 v35, v99
    v_and_or_b32 v27, v27, s13, v23
    v_pk_add_f32 v[28:29], v[28:29], v[4:5] op_sel_hi:[1,0]
    v_pk_add_f32 v[30:31], v[30:31], v[4:5] op_sel_hi:[1,0]
    v_pk_add_f32 v[32:33], v[32:33], v[4:5] op_sel_hi:[1,0]
    v_pk_add_f32 v[34:35], v[34:35], v[4:5] op_sel_hi:[1,0]
    v_rcp_f32 v28, v28
    v_rcp_f32 v29, v29
    v_rcp_f32 v30, v30
    v_rcp_f32 v31, v31
    v_rcp_f32 v32, v32
    v_rcp_f32 v33, v33
    v_rcp_f32 v34, v34
    v_rcp_f32 v35, v35
    s_cmp_eq_u32 s47, 13
    v_pk_fma_f32 v[156:157], v[92:93], v[28:29], v[156:157]
    v_pk_fma_f32 v[158:159], v[94:95], v[30:31], v[158:159]
    v_pk_fma_f32 v[160:161], v[96:97], v[32:33], v[160:161]
    v_pk_fma_f32 v[162:163], v[98:99], v[34:35], v[162:163]
    s_cbranch_scc1 M_FLUSH
    s_setprio 1
    v_mfma_f32_32x32x16_bf16 v[84:99], v[176:179], v[56:59], v[116:131]
    v_exp_f32 v28, v68
    v_and_or_b32 v4, v10, s14, 1.0
    v_exp_f32 v29, v69
    ds_read_b32 v10, v2 offset:34816
    v_exp_f32 v30, v70
    v_exp_f32 v31, v71
    v_exp_f32 v32, v72
    v_exp_f32 v33, v73
    v_exp_f32 v34, v74
    v_exp_f32 v35, v75
    v_pk_add_f32 v[28:29], v[28:29], v[4:5] op_sel_hi:[1,0]
    v_pk_add_f32 v[30:31], v[30:31], v[4:5] op_sel_hi:[1,0]
    v_pk_add_f32 v[32:33], v[32:33], v[4:5] op_sel_hi:[1,0]
    v_pk_add_f32 v[34:35], v[34:35], v[4:5] op_sel_hi:[1,0]
    v_smfmac_f32_32x32x32_bf16 v[84:99], v[164:167], v[44:51], v168
    v_rcp_f32 v28, v28
    v_rcp_f32 v29, v29
    v_rcp_f32 v30, v30
    s_waitcnt lgkmcnt(0)
    v_xor_b32 v236, v10, v9
    v_rcp_f32 v31, v31
    ds_read_b128 v[56:59], v236
    v_rcp_f32 v32, v32
    v_rcp_f32 v33, v33
    v_rcp_f32 v34, v34
    v_rcp_f32 v35, v35
    v_pk_fma_f32 v[132:133], v[68:69], v[28:29], v[132:133]
    v_pk_fma_f32 v[134:135], v[70:71], v[30:31], v[134:135]
    v_pk_fma_f32 v[136:137], v[72:73], v[32:33], v[136:137]
    v_pk_fma_f32 v[138:139], v[74:75], v[34:35], v[138:139]
    v_exp_f32 v28, v76
    s_waitcnt vmcnt(1)
    v_exp_f32 v29, v77
    ds_read_b128 v[36:39], v16
    v_exp_f32 v30, v78
    ds_read_b128 v[40:43], v17
    v_exp_f32 v31, v79
    ds_read_b128 v[44:47], v18
    v_exp_f32 v32, v80
    ds_read_b128 v[48:51], v19
    v_exp_f32 v33, v81
    v_exp_f32 v34, v82
    v_exp_f32 v35, v83
    s_add_u32 m0, s48, 0
    v_pk_add_f32 v[28:29], v[28:29], v[4:5] op_sel_hi:[1,0]
    v_pk_add_f32 v[30:31], v[30:31], v[4:5] op_sel_hi:[1,0]
    v_pk_add_f32 v[32:33], v[32:33], v[4:5] op_sel_hi:[1,0]
    v_pk_add_f32 v[34:35], v[34:35], v[4:5] op_sel_hi:[1,0]
    v_rcp_f32 v28, v28
    s_waitcnt lgkmcnt(0)
    buffer_load_dwordx4 v24, s[36:39], 0 offen sc1 lds
    v_rcp_f32 v29, v29
    s_add_u32 m0, s48, 1024
    v_rcp_f32 v30, v30
    buffer_load_dwordx4 v25, s[36:39], 0 offen sc1 lds
    v_rcp_f32 v31, v31
    s_add_u32 m0, s48, 2048
    v_rcp_f32 v32, v32
    buffer_load_dwordx4 v26, s[36:39], 0 offen sc1 lds
    v_rcp_f32 v33, v33
    s_add_u32 m0, s48, 3072
    v_rcp_f32 v34, v34
    buffer_load_dwordx4 v27, s[36:39], 0 offen sc1 lds
    v_rcp_f32 v35, v35
    v_pk_fma_f32 v[140:141], v[76:77], v[28:29], v[140:141]
    v_pk_fma_f32 v[142:143], v[78:79], v[30:31], v[142:143]
    v_pk_fma_f32 v[144:145], v[80:81], v[32:33], v[144:145]
    v_pk_fma_f32 v[146:147], v[82:83], v[34:35], v[146:147]
    s_setprio 0
    s_waitcnt vmcnt(4) lgkmcnt(0)
    v_mfma_f32_32x32x16_bf16 v[68:83], v[172:175], v[52:55], v[100:115]
    v_exp_f32 v28, v84
    v_exp_f32 v29, v85
    v_exp_f32 v30, v86
    v_exp_f32 v31, v87
    v_exp_f32 v32, v88
    ds_read_b128 v[24:27], v1 offset:18432
    v_exp_f32 v33, v89
    v_exp_f32 v34, v90
    v_exp_f32 v35, v91
    v_pk_add_f32 v[28:29], v[28:29], v[4:5] op_sel_hi:[1,0]
    v_pk_add_f32 v[30:31], v[30:31], v[4:5] op_sel_hi:[1,0]
    v_pk_add_f32 v[32:33], v[32:33], v[4:5] op_sel_hi:[1,0]
    v_pk_add_f32 v[34:35], v[34:35], v[4:5] op_sel_hi:[1,0]
    v_smfmac_f32_32x32x32_bf16 v[68:83], v[164:167], v[36:43], v168
    v_rcp_f32 v28, v28
    v_rcp_f32 v29, v29
    v_rcp_f32 v30, v30
    v_rcp_f32 v31, v31
    v_cmp_le_u32 vcc, s15, v10
    v_rcp_f32 v32, v32
    s_mov_b64 exec, vcc
    buffer_load_dwordx4 v[56:59], v[10:11], s[20:23], 0 idxen offen
    s_mov_b64 exec, -1
    v_rcp_f32 v33, v33
    v_rcp_f32 v34, v34
    v_rcp_f32 v35, v35
    v_pk_fma_f32 v[148:149], v[84:85], v[28:29], v[148:149]
    v_pk_fma_f32 v[150:151], v[86:87], v[30:31], v[150:151]
    v_pk_fma_f32 v[152:153], v[88:89], v[32:33], v[152:153]
    v_pk_fma_f32 v[154:155], v[90:91], v[34:35], v[154:155]
    v_exp_f32 v28, v92
    v_exp_f32 v29, v93
    v_exp_f32 v30, v94
    v_exp_f32 v31, v95
    v_exp_f32 v32, v96
    s_waitcnt lgkmcnt(0)
    v_and_or_b32 v24, v24, s13, v20
    v_exp_f32 v33, v97
    v_and_or_b32 v25, v25, s13, v21
    v_exp_f32 v34, v98
    v_and_or_b32 v26, v26, s13, v22
    v_exp_f32 v35, v99
    v_and_or_b32 v27, v27, s13, v23
    v_pk_add_f32 v[28:29], v[28:29], v[4:5] op_sel_hi:[1,0]
    v_pk_add_f32 v[30:31], v[30:31], v[4:5] op_sel_hi:[1,0]
    v_pk_add_f32 v[32:33], v[32:33], v[4:5] op_sel_hi:[1,0]
    v_pk_add_f32 v[34:35], v[34:35], v[4:5] op_sel_hi:[1,0]
    v_rcp_f32 v28, v28
    v_rcp_f32 v29, v29
    v_rcp_f32 v30, v30
    v_rcp_f32 v31, v31
    v_rcp_f32 v32, v32
    v_rcp_f32 v33, v33
    v_rcp_f32 v34, v34
    v_rcp_f32 v35, v35
    s_cmp_eq_u32 s47, 14
    v_pk_fma_f32 v[156:157], v[92:93], v[28:29], v[156:157]
    v_pk_fma_f32 v[158:159], v[94:95], v[30:31], v[158:159]
    v_pk_fma_f32 v[160:161], v[96:97], v[32:33], v[160:161]
    v_pk_fma_f32 v[162:163], v[98:99], v[34:35], v[162:163]
    s_cbranch_scc1 M_FLUSH
    s_setprio 1
    v_mfma_f32_32x32x16_bf16 v[84:99], v[176:179], v[52:55], v[116:131]
    v_exp_f32 v28, v68
    v_and_or_b32 v4, v8, s14, 1.0
    v_exp_f32 v29, v69
    ds_read_b32 v8, v2 offset:35840
    v_exp_f32 v30, v70
    v_exp_f32 v31, v71
    v_exp_f32 v32, v72
    v_exp_f32 v33, v73
    v_exp_f32 v34, v74
    v_exp_f32 v35, v75
    v_pk_add_f32 v[28:29], v[28:29], v[4:5] op_sel_hi:[1,0]
    v_pk_add_f32 v[30:31], v[30:31], v[4:5] op_sel_hi:[1,0]
    v_pk_add_f32 v[32:33], v[32:33], v[4:5] op_sel_hi:[1,0]
    v_pk_add_f32 v[34:35], v[34:35], v[4:5] op_sel_hi:[1,0]
    v_smfmac_f32_32x32x32_bf16 v[84:99], v[164:167], v[44:51], v168
    v_rcp_f32 v28, v28
    v_rcp_f32 v29, v29
    v_rcp_f32 v30, v30
    s_waitcnt lgkmcnt(0)
    v_xor_b32 v236, v8, v9
    v_rcp_f32 v31, v31
    ds_read_b128 v[52:55], v236
    v_rcp_f32 v32, v32
    v_rcp_f32 v33, v33
    v_rcp_f32 v34, v34
    v_rcp_f32 v35, v35
    v_pk_fma_f32 v[132:133], v[68:69], v[28:29], v[132:133]
    v_pk_fma_f32 v[134:135], v[70:71], v[30:31], v[134:135]
    v_pk_fma_f32 v[136:137], v[72:73], v[32:33], v[136:137]
    v_pk_fma_f32 v[138:139], v[74:75], v[34:35], v[138:139]
    v_exp_f32 v28, v76
    s_waitcnt vmcnt(1)
    v_exp_f32 v29, v77
    ds_read_b128 v[36:39], v16
    v_exp_f32 v30, v78
    ds_read_b128 v[40:43], v17
    v_exp_f32 v31, v79
    ds_read_b128 v[44:47], v18
    v_exp_f32 v32, v80
    ds_read_b128 v[48:51], v19
    v_exp_f32 v33, v81
    v_exp_f32 v34, v82
    v_exp_f32 v35, v83
    s_add_u32 m0, s48, 0
    v_pk_add_f32 v[28:29], v[28:29], v[4:5] op_sel_hi:[1,0]
    v_pk_add_f32 v[30:31], v[30:31], v[4:5] op_sel_hi:[1,0]
    v_pk_add_f32 v[32:33], v[32:33], v[4:5] op_sel_hi:[1,0]
    v_pk_add_f32 v[34:35], v[34:35], v[4:5] op_sel_hi:[1,0]
    v_rcp_f32 v28, v28
    s_waitcnt lgkmcnt(0)
    buffer_load_dwordx4 v24, s[36:39], 0 offen sc1 lds
    v_rcp_f32 v29, v29
    s_add_u32 m0, s48, 1024
    v_rcp_f32 v30, v30
    buffer_load_dwordx4 v25, s[36:39], 0 offen sc1 lds
    v_rcp_f32 v31, v31
    s_add_u32 m0, s48, 2048
    v_rcp_f32 v32, v32
    buffer_load_dwordx4 v26, s[36:39], 0 offen sc1 lds
    v_rcp_f32 v33, v33
    s_add_u32 m0, s48, 3072
    v_rcp_f32 v34, v34
    buffer_load_dwordx4 v27, s[36:39], 0 offen sc1 lds
    v_rcp_f32 v35, v35
    v_pk_fma_f32 v[140:141], v[76:77], v[28:29], v[140:141]
    v_pk_fma_f32 v[142:143], v[78:79], v[30:31], v[142:143]
    v_pk_fma_f32 v[144:145], v[80:81], v[32:33], v[144:145]
    v_pk_fma_f32 v[146:147], v[82:83], v[34:35], v[146:147]
    s_setprio 0
    s_waitcnt vmcnt(4) lgkmcnt(0)
    v_mfma_f32_32x32x16_bf16 v[68:83], v[172:175], v[56:59], v[100:115]
    v_exp_f32 v28, v84
    v_exp_f32 v29, v85
    v_exp_f32 v30, v86
    v_exp_f32 v31, v87
    v_exp_f32 v32, v88
    v_exp_f32 v33, v89
    v_exp_f32 v34, v90
    v_exp_f32 v35, v91
    v_pk_add_f32 v[28:29], v[28:29], v[4:5] op_sel_hi:[1,0]
    v_pk_add_f32 v[30:31], v[30:31], v[4:5] op_sel_hi:[1,0]
    v_pk_add_f32 v[32:33], v[32:33], v[4:5] op_sel_hi:[1,0]
    v_pk_add_f32 v[34:35], v[34:35], v[4:5] op_sel_hi:[1,0]
    v_smfmac_f32_32x32x32_bf16 v[68:83], v[164:167], v[36:43], v168
    v_rcp_f32 v28, v28
    v_rcp_f32 v29, v29
    v_rcp_f32 v30, v30
    v_rcp_f32 v31, v31
    v_cmp_le_u32 vcc, s15, v8
    v_rcp_f32 v32, v32
    s_mov_b64 exec, vcc
    buffer_load_dwordx4 v[52:55], v[8:9], s[20:23], 0 idxen offen
    s_mov_b64 exec, -1
    v_rcp_f32 v33, v33
    v_rcp_f32 v34, v34
    v_rcp_f32 v35, v35
    v_pk_fma_f32 v[148:149], v[84:85], v[28:29], v[148:149]
    v_pk_fma_f32 v[150:151], v[86:87], v[30:31], v[150:151]
    v_pk_fma_f32 v[152:153], v[88:89], v[32:33], v[152:153]
    v_pk_fma_f32 v[154:155], v[90:91], v[34:35], v[154:155]
    v_exp_f32 v28, v92
    v_exp_f32 v29, v93
    v_exp_f32 v30, v94
    v_exp_f32 v31, v95
    v_exp_f32 v32, v96
    v_exp_f32 v33, v97
    v_exp_f32 v34, v98
    v_exp_f32 v35, v99
    v_pk_add_f32 v[28:29], v[28:29], v[4:5] op_sel_hi:[1,0]
    v_pk_add_f32 v[30:31], v[30:31], v[4:5] op_sel_hi:[1,0]
    v_pk_add_f32 v[32:33], v[32:33], v[4:5] op_sel_hi:[1,0]
    v_pk_add_f32 v[34:35], v[34:35], v[4:5] op_sel_hi:[1,0]
    v_rcp_f32 v28, v28
    v_rcp_f32 v29, v29
    v_rcp_f32 v30, v30
    v_rcp_f32 v31, v31
    v_rcp_f32 v32, v32
    v_rcp_f32 v33, v33
    v_rcp_f32 v34, v34
    v_rcp_f32 v35, v35
    s_cmp_eq_u32 s47, 15
    v_pk_fma_f32 v[156:157], v[92:93], v[28:29], v[156:157]
    v_pk_fma_f32 v[158:159], v[94:95], v[30:31], v[158:159]
    v_pk_fma_f32 v[160:161], v[96:97], v[32:33], v[160:161]
    v_pk_fma_f32 v[162:163], v[98:99], v[34:35], v[162:163]
    s_cbranch_scc1 M_FLUSH
    s_setprio 1
    v_mfma_f32_32x32x16_bf16 v[84:99], v[176:179], v[56:59], v[116:131]
    v_exp_f32 v28, v68
    v_and_or_b32 v4, v10, s14, 1.0
    v_exp_f32 v29, v69
    v_exp_f32 v30, v70
    v_exp_f32 v31, v71
    v_exp_f32 v32, v72
    v_exp_f32 v33, v73
    v_exp_f32 v34, v74
    v_exp_f32 v35, v75
    v_pk_add_f32 v[28:29], v[28:29], v[4:5] op_sel_hi:[1,0]
    v_pk_add_f32 v[30:31], v[30:31], v[4:5] op_sel_hi:[1,0]
    v_pk_add_f32 v[32:33], v[32:33], v[4:5] op_sel_hi:[1,0]
    v_pk_add_f32 v[34:35], v[34:35], v[4:5] op_sel_hi:[1,0]
    v_smfmac_f32_32x32x32_bf16 v[84:99], v[164:167], v[44:51], v168
    v_rcp_f32 v28, v28
    v_rcp_f32 v29, v29
    v_rcp_f32 v30, v30
    v_rcp_f32 v31, v31
    v_rcp_f32 v32, v32
    v_rcp_f32 v33, v33
    v_rcp_f32 v34, v34
    v_rcp_f32 v35, v35
    v_pk_fma_f32 v[132:133], v[68:69], v[28:29], v[132:133]
    v_pk_fma_f32 v[134:135], v[70:71], v[30:31], v[134:135]
    v_pk_fma_f32 v[136:137], v[72:73], v[32:33], v[136:137]
    v_pk_fma_f32 v[138:139], v[74:75], v[34:35], v[138:139]
    v_exp_f32 v28, v76
    s_waitcnt vmcnt(1)
    v_exp_f32 v29, v77
    ds_read_b128 v[36:39], v16
    v_exp_f32 v30, v78
    ds_read_b128 v[40:43], v17
    v_exp_f32 v31, v79
    ds_read_b128 v[44:47], v18
    v_exp_f32 v32, v80
    ds_read_b128 v[48:51], v19
    v_exp_f32 v33, v81
    v_exp_f32 v34, v82
    v_exp_f32 v35, v83
    v_pk_add_f32 v[28:29], v[28:29], v[4:5] op_sel_hi:[1,0]
    v_pk_add_f32 v[30:31], v[30:31], v[4:5] op_sel_hi:[1,0]
    v_pk_add_f32 v[32:33], v[32:33], v[4:5] op_sel_hi:[1,0]
    v_pk_add_f32 v[34:35], v[34:35], v[4:5] op_sel_hi:[1,0]
    v_rcp_f32 v28, v28
    v_rcp_f32 v29, v29
    v_rcp_f32 v30, v30
    v_rcp_f32 v31, v31
    v_rcp_f32 v32, v32
    v_rcp_f32 v33, v33
    v_rcp_f32 v34, v34
    v_rcp_f32 v35, v35
    v_pk_fma_f32 v[140:141], v[76:77], v[28:29], v[140:141]
    v_pk_fma_f32 v[142:143], v[78:79], v[30:31], v[142:143]
    v_pk_fma_f32 v[144:145], v[80:81], v[32:33], v[144:145]
    v_pk_fma_f32 v[146:147], v[82:83], v[34:35], v[146:147]
    s_setprio 0
    s_waitcnt vmcnt(0) lgkmcnt(0)
    v_mfma_f32_32x32x16_bf16 v[68:83], v[172:175], v[52:55], v[100:115]
    v_exp_f32 v28, v84
    v_exp_f32 v29, v85
    v_exp_f32 v30, v86
    v_exp_f32 v31, v87
    v_exp_f32 v32, v88
    v_exp_f32 v33, v89
    v_exp_f32 v34, v90
    v_exp_f32 v35, v91
    v_pk_add_f32 v[28:29], v[28:29], v[4:5] op_sel_hi:[1,0]
    v_pk_add_f32 v[30:31], v[30:31], v[4:5] op_sel_hi:[1,0]
    v_pk_add_f32 v[32:33], v[32:33], v[4:5] op_sel_hi:[1,0]
    v_pk_add_f32 v[34:35], v[34:35], v[4:5] op_sel_hi:[1,0]
    v_smfmac_f32_32x32x32_bf16 v[68:83], v[164:167], v[36:43], v168
    v_rcp_f32 v28, v28
    v_rcp_f32 v29, v29
    v_rcp_f32 v30, v30
    v_rcp_f32 v31, v31
    v_rcp_f32 v32, v32
    v_rcp_f32 v33, v33
    v_rcp_f32 v34, v34
    v_rcp_f32 v35, v35
    v_pk_fma_f32 v[148:149], v[84:85], v[28:29], v[148:149]
    v_pk_fma_f32 v[150:151], v[86:87], v[30:31], v[150:151]
    v_pk_fma_f32 v[152:153], v[88:89], v[32:33], v[152:153]
    v_pk_fma_f32 v[154:155], v[90:91], v[34:35], v[154:155]
    v_exp_f32 v28, v92
    v_exp_f32 v29, v93
    v_exp_f32 v30, v94
    v_exp_f32 v31, v95
    v_exp_f32 v32, v96
    v_exp_f32 v33, v97
    v_exp_f32 v34, v98
    v_exp_f32 v35, v99
    v_pk_add_f32 v[28:29], v[28:29], v[4:5] op_sel_hi:[1,0]
    v_pk_add_f32 v[30:31], v[30:31], v[4:5] op_sel_hi:[1,0]
    v_pk_add_f32 v[32:33], v[32:33], v[4:5] op_sel_hi:[1,0]
    v_pk_add_f32 v[34:35], v[34:35], v[4:5] op_sel_hi:[1,0]
    v_rcp_f32 v28, v28
    v_rcp_f32 v29, v29
    v_rcp_f32 v30, v30
    v_rcp_f32 v31, v31
    v_rcp_f32 v32, v32
    v_rcp_f32 v33, v33
    v_rcp_f32 v34, v34
    v_rcp_f32 v35, v35
    s_cmp_eq_u32 s47, 16
    v_pk_fma_f32 v[156:157], v[92:93], v[28:29], v[156:157]
    v_pk_fma_f32 v[158:159], v[94:95], v[30:31], v[158:159]
    v_pk_fma_f32 v[160:161], v[96:97], v[32:33], v[160:161]
    v_pk_fma_f32 v[162:163], v[98:99], v[34:35], v[162:163]
    s_cbranch_scc1 M_FLUSH
    s_setprio 1
    v_mfma_f32_32x32x16_bf16 v[84:99], v[176:179], v[52:55], v[116:131]
    v_exp_f32 v28, v68
    v_and_or_b32 v4, v8, s14, 1.0
    v_exp_f32 v29, v69
    v_exp_f32 v30, v70
    v_exp_f32 v31, v71
    v_exp_f32 v32, v72
    v_exp_f32 v33, v73
    v_exp_f32 v34, v74
    v_exp_f32 v35, v75
    v_pk_add_f32 v[28:29], v[28:29], v[4:5] op_sel_hi:[1,0]
    v_pk_add_f32 v[30:31], v[30:31], v[4:5] op_sel_hi:[1,0]
    v_pk_add_f32 v[32:33], v[32:33], v[4:5] op_sel_hi:[1,0]
    v_pk_add_f32 v[34:35], v[34:35], v[4:5] op_sel_hi:[1,0]
    v_smfmac_f32_32x32x32_bf16 v[84:99], v[164:167], v[44:51], v168
    v_rcp_f32 v28, v28
    v_rcp_f32 v29, v29
    v_rcp_f32 v30, v30
    v_rcp_f32 v31, v31
    v_rcp_f32 v32, v32
    v_rcp_f32 v33, v33
    v_rcp_f32 v34, v34
    v_rcp_f32 v35, v35
    v_pk_fma_f32 v[132:133], v[68:69], v[28:29], v[132:133]
    v_pk_fma_f32 v[134:135], v[70:71], v[30:31], v[134:135]
    v_pk_fma_f32 v[136:137], v[72:73], v[32:33], v[136:137]
    v_pk_fma_f32 v[138:139], v[74:75], v[34:35], v[138:139]
    v_exp_f32 v28, v76
    v_exp_f32 v29, v77
    v_exp_f32 v30, v78
    v_exp_f32 v31, v79
    v_exp_f32 v32, v80
    v_exp_f32 v33, v81
    v_exp_f32 v34, v82
    v_exp_f32 v35, v83
    v_pk_add_f32 v[28:29], v[28:29], v[4:5] op_sel_hi:[1,0]
    v_pk_add_f32 v[30:31], v[30:31], v[4:5] op_sel_hi:[1,0]
    v_pk_add_f32 v[32:33], v[32:33], v[4:5] op_sel_hi:[1,0]
    v_pk_add_f32 v[34:35], v[34:35], v[4:5] op_sel_hi:[1,0]
    v_rcp_f32 v28, v28
    v_rcp_f32 v29, v29
    v_rcp_f32 v30, v30
    v_rcp_f32 v31, v31
    v_rcp_f32 v32, v32
    v_rcp_f32 v33, v33
    v_rcp_f32 v34, v34
    v_rcp_f32 v35, v35
    v_pk_fma_f32 v[140:141], v[76:77], v[28:29], v[140:141]
    v_pk_fma_f32 v[142:143], v[78:79], v[30:31], v[142:143]
    v_pk_fma_f32 v[144:145], v[80:81], v[32:33], v[144:145]
    v_pk_fma_f32 v[146:147], v[82:83], v[34:35], v[146:147]
    s_setprio 0
    v_exp_f32 v28, v84
    v_exp_f32 v29, v85
    v_exp_f32 v30, v86
    v_exp_f32 v31, v87
    v_exp_f32 v32, v88
    v_exp_f32 v33, v89
    v_exp_f32 v34, v90
    v_exp_f32 v35, v91
    v_pk_add_f32 v[28:29], v[28:29], v[4:5] op_sel_hi:[1,0]
    v_pk_add_f32 v[30:31], v[30:31], v[4:5] op_sel_hi:[1,0]
    v_pk_add_f32 v[32:33], v[32:33], v[4:5] op_sel_hi:[1,0]
    v_pk_add_f32 v[34:35], v[34:35], v[4:5] op_sel_hi:[1,0]
    v_rcp_f32 v28, v28
    v_rcp_f32 v29, v29
    v_rcp_f32 v30, v30
    v_rcp_f32 v31, v31
    v_rcp_f32 v32, v32
    v_rcp_f32 v33, v33
    v_rcp_f32 v34, v34
    v_rcp_f32 v35, v35
    v_pk_fma_f32 v[148:149], v[84:85], v[28:29], v[148:149]
    v_pk_fma_f32 v[150:151], v[86:87], v[30:31], v[150:151]
    v_pk_fma_f32 v[152:153], v[88:89], v[32:33], v[152:153]
    v_pk_fma_f32 v[154:155], v[90:91], v[34:35], v[154:155]
    v_exp_f32 v28, v92
    v_exp_f32 v29, v93
    v_exp_f32 v30, v94
    v_exp_f32 v31, v95
    v_exp_f32 v32, v96
    v_exp_f32 v33, v97
    v_exp_f32 v34, v98
    v_exp_f32 v35, v99
    v_pk_add_f32 v[28:29], v[28:29], v[4:5] op_sel_hi:[1,0]
    v_pk_add_f32 v[30:31], v[30:31], v[4:5] op_sel_hi:[1,0]
    v_pk_add_f32 v[32:33], v[32:33], v[4:5] op_sel_hi:[1,0]
    v_pk_add_f32 v[34:35], v[34:35], v[4:5] op_sel_hi:[1,0]
    v_rcp_f32 v28, v28
    v_rcp_f32 v29, v29
    v_rcp_f32 v30, v30
    v_rcp_f32 v31, v31
    v_rcp_f32 v32, v32
    v_rcp_f32 v33, v33
    v_rcp_f32 v34, v34
    v_rcp_f32 v35, v35
    s_cmp_eq_u32 s47, 17
    v_pk_fma_f32 v[156:157], v[92:93], v[28:29], v[156:157]
    v_pk_fma_f32 v[158:159], v[94:95], v[30:31], v[158:159]
    v_pk_fma_f32 v[160:161], v[96:97], v[32:33], v[160:161]
    v_pk_fma_f32 v[162:163], v[98:99], v[34:35], v[162:163]
M_FLUSH:
    s_waitcnt vmcnt(0)
    ds_write_b128 v219, v[132:135] offset:0
    ds_write_b128 v219, v[136:139] offset:32
    ds_write_b128 v219, v[140:143] offset:64
    ds_write_b128 v219, v[144:147] offset:96
    ds_write_b128 v219, v[148:151] offset:128
    ds_write_b128 v219, v[152:155] offset:160
    ds_write_b128 v219, v[156:159] offset:192
    ds_write_b128 v219, v[160:163] offset:224
M_BEND:
    v_cmp_gt_u32 vcc, 0x3f4, v216
    s_mov_b32 s74, 0xbf317218
    s_mov_b32 s75, 0xbf317218
    s_waitcnt lgkmcnt(0)
    s_barrier
    ds_read_b128 v[68:71], v212 offset:0
    ds_read_b128 v[84:87], v213 offset:0
    ds_read_b128 v[100:103], v214 offset:0
    ds_read_b128 v[72:75], v212 offset:16
    ds_read_b128 v[88:91], v213 offset:16
    ds_read_b128 v[104:107], v214 offset:16
    ds_read_b128 v[76:79], v212 offset:64
    ds_read_b128 v[92:95], v213 offset:64
    ds_read_b128 v[108:111], v214 offset:64
    ds_read_b128 v[80:83], v212 offset:80
    ds_read_b128 v[96:99], v213 offset:80
    ds_read_b128 v[112:115], v214 offset:80
    s_waitcnt lgkmcnt(9)
    v_pk_add_f32 v[68:69], v[68:69], v[84:85]
    v_pk_add_f32 v[70:71], v[70:71], v[86:87]
    v_pk_add_f32 v[68:69], v[68:69], v[100:101]
    v_pk_add_f32 v[70:71], v[70:71], v[102:103]
    s_waitcnt lgkmcnt(6)
    v_pk_add_f32 v[72:73], v[72:73], v[88:89]
    v_pk_add_f32 v[74:75], v[74:75], v[90:91]
    v_pk_add_f32 v[72:73], v[72:73], v[104:105]
    v_pk_add_f32 v[74:75], v[74:75], v[106:107]
    s_waitcnt lgkmcnt(3)
    v_pk_add_f32 v[76:77], v[76:77], v[92:93]
    v_pk_add_f32 v[78:79], v[78:79], v[94:95]
    v_pk_add_f32 v[76:77], v[76:77], v[108:109]
    v_pk_add_f32 v[78:79], v[78:79], v[110:111]
    s_waitcnt lgkmcnt(0)
    v_pk_add_f32 v[80:81], v[80:81], v[96:97]
    v_pk_add_f32 v[82:83], v[82:83], v[98:99]
    v_pk_add_f32 v[80:81], v[80:81], v[112:113]
    v_pk_add_f32 v[82:83], v[82:83], v[114:115]
    s_cbranch_vccz M_SUMD
    s_movk_i32 s49, 0x3f4
M_SUML:
    s_mov_b64 exec, vcc
    ds_read_b128 v[84:87], v215 offset:0
    ds_read_b128 v[88:91], v215 offset:16
    ds_read_b128 v[92:95], v215 offset:64
    ds_read_b128 v[96:99], v215 offset:80
    s_sub_u32 s49, s49, 4
    v_add_u32 v215, 272, v215
    s_waitcnt lgkmcnt(0)
    v_pk_add_f32 v[68:69], v[68:69], v[84:85]
    v_pk_add_f32 v[70:71], v[70:71], v[86:87]
    v_pk_add_f32 v[72:73], v[72:73], v[88:89]
    v_pk_add_f32 v[74:75], v[74:75], v[90:91]
    v_pk_add_f32 v[76:77], v[76:77], v[92:93]
    v_pk_add_f32 v[78:79], v[78:79], v[94:95]
    v_pk_add_f32 v[80:81], v[80:81], v[96:97]
    v_pk_add_f32 v[82:83], v[82:83], v[98:99]
    s_mov_b64 exec, -1
    v_cmp_gt_i32 vcc, s49, v216
    s_nop 4
    s_cbranch_vccnz M_SUML
M_SUMD:
    s_cmp_le_u32 s72, s51
    s_cbranch_scc1 M_EPI
    s_add_u32 s56, s10, 27262976
    s_addc_u32 s57, s11, 0
    s_mov_b32 s58, 8388608
    s_mov_b32 s59, 0x20000
    s_lshl_b32 s49, s2, 3
    s_add_u32 s49, s49, s40
    s_lshl_b32 s49, s49, 12
    s_cmp_eq_u32 s45, 0
    s_cbranch_scc1 M_NOLD
    buffer_load_dwordx4 v[84:87], v238, s[56:59], s49 offen offset:0 sc0 sc1
    buffer_load_dwordx4 v[88:91], v238, s[56:59], s49 offen offset:1024 sc0 sc1
    buffer_load_dwordx4 v[92:95], v238, s[56:59], s49 offen offset:2048 sc0 sc1
    buffer_load_dwordx4 v[96:99], v238, s[56:59], s49 offen offset:3072 sc0 sc1
    s_waitcnt vmcnt(0)
    v_pk_add_f32 v[68:69], v[68:69], v[84:85]
    v_pk_add_f32 v[70:71], v[70:71], v[86:87]
    v_pk_add_f32 v[72:73], v[72:73], v[88:89]
    v_pk_add_f32 v[74:75], v[74:75], v[90:91]
    v_pk_add_f32 v[76:77], v[76:77], v[92:93]
    v_pk_add_f32 v[78:79], v[78:79], v[94:95]
    v_pk_add_f32 v[80:81], v[80:81], v[96:97]
    v_pk_add_f32 v[82:83], v[82:83], v[98:99]
M_NOLD:
    s_add_u32 s45, s45, s51
    s_cmp_ge_u32 s45, s72
    s_cbranch_scc1 M_EPI
    buffer_store_dwordx4 v[68:71], v238, s[56:59], s49 offen offset:0 sc0 sc1
    buffer_store_dwordx4 v[72:75], v238, s[56:59], s49 offen offset:1024 sc0 sc1
    buffer_store_dwordx4 v[76:79], v238, s[56:59], s49 offen offset:2048 sc0 sc1
    buffer_store_dwordx4 v[80:83], v238, s[56:59], s49 offen offset:3072 sc0 sc1
M_AGAIN:
    s_load_dwordx2 s[60:61], s[0:1], 32
    s_waitcnt vmcnt(0) lgkmcnt(0)
    s_barrier
    s_mov_b32 s56, s60
    s_mov_b32 s57, s61
    s_mov_b32 s58, 18432
    s_mov_b32 s59, 0x20000
    s_lshl_b32 s49, s40, 10
    s_add_u32 s49, s49, 8192
    s_add_u32 m0, s49, 2048
    v_lshlrev_b32 v28, 2, v0
    buffer_load_dwordx4 v238, s[56:59], s49 offen lds
    ds_write_b32 v28, v246
    v_add_u32 v28, 102912, v28
    ds_write_b32 v28, v246
    ds_write_b32 v28, v246 offset:2048
    s_waitcnt vmcnt(0)
    s_barrier
    ds_read_b64_tr_b16 v[132:133], v244 offset:10240
    ds_read_b64_tr_b16 v[134:135], v244 offset:10752
    ds_read_b64_tr_b16 v[136:137], v244 offset:10304
    ds_read_b64_tr_b16 v[138:139], v244 offset:10816
    ds_read_b64_tr_b16 v[140:141], v244 offset:12288
    ds_read_b64_tr_b16 v[142:143], v244 offset:12800
    ds_read_b64_tr_b16 v[144:145], v244 offset:12352
    ds_read_b64_tr_b16 v[146:147], v244 offset:12864
    ds_read_b64_tr_b16 v[148:149], v244 offset:14336
    ds_read_b64_tr_b16 v[150:151], v244 offset:14848
    ds_read_b64_tr_b16 v[152:153], v244 offset:14400
    ds_read_b64_tr_b16 v[154:155], v244 offset:14912
    ds_read_b64_tr_b16 v[156:157], v244 offset:16384
    ds_read_b64_tr_b16 v[158:159], v244 offset:16896
    ds_read_b64_tr_b16 v[160:161], v244 offset:16448
    ds_read_b64_tr_b16 v[162:163], v244 offset:16960
    s_waitcnt lgkmcnt(0)
    s_barrier
    s_branch M_BATCH
M_EPI:
    s_mov_b32 s56, s8
    s_mov_b32 s57, s9
    s_mov_b32 s58, 3200000
    s_mov_b32 s59, 0x20000
    v_pk_mul_f32 v[68:69], v[68:69], s[74:75]
    v_pk_mul_f32 v[70:71], v[70:71], s[74:75]
    v_pk_mul_f32 v[72:73], v[72:73], s[74:75]
    v_pk_mul_f32 v[74:75], v[74:75], s[74:75]
    v_pk_mul_f32 v[76:77], v[76:77], s[74:75]
    v_pk_mul_f32 v[78:79], v[78:79], s[74:75]
    v_pk_mul_f32 v[80:81], v[80:81], s[74:75]
    v_pk_mul_f32 v[82:83], v[82:83], s[74:75]
    v_cvt_pk_bf16_f32 v116, v68, v69
    v_cvt_pk_bf16_f32 v117, v70, v71
    v_cvt_pk_bf16_f32 v118, v72, v73
    v_cvt_pk_bf16_f32 v119, v74, v75
    v_cvt_pk_bf16_f32 v120, v76, v77
    v_cvt_pk_bf16_f32 v121, v78, v79
    v_cvt_pk_bf16_f32 v122, v80, v81
    v_cvt_pk_bf16_f32 v123, v82, v83
    ds_write_b128 v218, v[116:119] offset:2048
    ds_write_b128 v218, v[120:123] offset:3072
    v_xor_b32 v218, 0x800, v218
    v_mfma_f32_32x32x16_bf16 v[180:195], v[196:199], v[116:119], v[180:195]
    v_mfma_f32_32x32x16_bf16 v[180:195], v[200:203], v[120:123], v[180:195]
    s_lshl_b32 s49, s41, 6
    s_add_u32 s49, s49, s42
    s_mov_b32 s74, 0xbfb8aa3b
    s_mov_b32 s75, 0xbfb8aa3b
    s_waitcnt lgkmcnt(0)
    s_barrier
    ds_read_b128 v[124:127], v218 offset:2048
    ds_read_b128 v[128:131], v218 offset:3072
    s_waitcnt lgkmcnt(1)
    v_mfma_f32_32x32x16_bf16 v[180:195], v[204:207], v[124:127], v[180:195]
    s_waitcnt lgkmcnt(0)
    v_mfma_f32_32x32x16_bf16 v[180:195], v[208:211], v[128:131], v[180:195]
    s_nop 11
    v_pk_mul_f32 v[132:133], v[180:181], s[74:75]
    v_pk_mul_f32 v[134:135], v[182:183], s[74:75]
    v_pk_mul_f32 v[136:137], v[184:185], s[74:75]
    v_pk_mul_f32 v[138:139], v[186:187], s[74:75]
    v_exp_f32 v132, v132
    v_exp_f32 v133, v133
    v_exp_f32 v134, v134
    v_exp_f32 v135, v135
    v_exp_f32 v136, v136
    v_exp_f32 v137, v137
    v_exp_f32 v138, v138
    v_exp_f32 v139, v139
    v_pk_add_f32 v[132:133], v[132:133], 1.0 op_sel_hi:[1,0]
    v_pk_add_f32 v[134:135], v[134:135], 1.0 op_sel_hi:[1,0]
    v_pk_add_f32 v[136:137], v[136:137], 1.0 op_sel_hi:[1,0]
    v_pk_add_f32 v[138:139], v[138:139], 1.0 op_sel_hi:[1,0]
    v_rcp_f32 v132, v132
    v_rcp_f32 v133, v133
    v_rcp_f32 v134, v134
    v_rcp_f32 v135, v135
    v_rcp_f32 v136, v136
    v_rcp_f32 v137, v137
    v_rcp_f32 v138, v138
    v_rcp_f32 v139, v139
    v_pk_mul_f32 v[132:133], v[180:181], v[132:133]
    v_pk_mul_f32 v[134:135], v[182:183], v[134:135]
    v_pk_mul_f32 v[136:137], v[184:185], v[136:137]
    v_pk_mul_f32 v[138:139], v[186:187], v[138:139]
    v_cvt_pk_bf16_f32 v68, v132, v133
    v_cvt_pk_bf16_f32 v69, v134, v135
    v_cvt_pk_bf16_f32 v70, v136, v137
    v_cvt_pk_bf16_f32 v71, v138, v139
    buffer_store_dwordx4 v[68:71], v217, s[56:59], s49 offen offset:0
    v_pk_mul_f32 v[140:141], v[188:189], s[74:75]
    v_pk_mul_f32 v[142:143], v[190:191], s[74:75]
    v_pk_mul_f32 v[144:145], v[192:193], s[74:75]
    v_pk_mul_f32 v[146:147], v[194:195], s[74:75]
    v_exp_f32 v140, v140
    v_exp_f32 v141, v141
    v_exp_f32 v142, v142
    v_exp_f32 v143, v143
    v_exp_f32 v144, v144
    v_exp_f32 v145, v145
    v_exp_f32 v146, v146
    v_exp_f32 v147, v147
    v_pk_add_f32 v[140:141], v[140:141], 1.0 op_sel_hi:[1,0]
    v_pk_add_f32 v[142:143], v[142:143], 1.0 op_sel_hi:[1,0]
    v_pk_add_f32 v[144:145], v[144:145], 1.0 op_sel_hi:[1,0]
    v_pk_add_f32 v[146:147], v[146:147], 1.0 op_sel_hi:[1,0]
    v_rcp_f32 v140, v140
    v_rcp_f32 v141, v141
    v_rcp_f32 v142, v142
    v_rcp_f32 v143, v143
    v_rcp_f32 v144, v144
    v_rcp_f32 v145, v145
    v_rcp_f32 v146, v146
    v_rcp_f32 v147, v147
    v_pk_mul_f32 v[140:141], v[188:189], v[140:141]
    v_pk_mul_f32 v[142:143], v[190:191], v[142:143]
    v_pk_mul_f32 v[144:145], v[192:193], v[144:145]
    v_pk_mul_f32 v[146:147], v[194:195], v[146:147]
    v_cvt_pk_bf16_f32 v72, v140, v141
    v_cvt_pk_bf16_f32 v73, v142, v143
    v_cvt_pk_bf16_f32 v74, v144, v145
    v_cvt_pk_bf16_f32 v75, v146, v147
    buffer_store_dwordx4 v[72:75], v217, s[56:59], s49 offen offset:16
M_END:
    s_endpgm
.section .rodata,"a"
.p2align 6
.amdhsa_kernel standalone__mpnn_edge_mlp__graph_kernel
  .amdhsa_next_free_vgpr 256
  .amdhsa_next_free_sgpr 102
  .amdhsa_accum_offset 256
  .amdhsa_group_segment_fixed_size 0
  .amdhsa_kernarg_size 72
  .amdhsa_user_sgpr_count 2
  .amdhsa_user_sgpr_kernarg_segment_ptr 1
  .amdhsa_system_sgpr_workgroup_id_x 1
.end_amdhsa_kernel
```
